```python
import torch

def _softmax(x, axis=-1):
    return torch.softmax(x, dim=axis)
def _gelu(x):
    return torch.nn.functional.gelu(x, approximate="tanh")
def _silu(x):
    return torch.nn.functional.silu(x)
def _sigmoid(x):
    return torch.sigmoid(x)
def _layernorm(x, axis=-1, eps=1e-5):
    m = x.mean(dim=axis, keepdim=True)
    v = x.var(dim=axis, keepdim=True, unbiased=False)
    return (x - m) / torch.sqrt(v + eps)
def _scatter_add(tgt, idx, src, axis=0):
    return tgt.clone().index_add_(axis, idx, src)
def _segment_sum(src, seg, n):
    out = torch.zeros((n,) + src.shape[1:], dtype=src.dtype)
    return out.index_add_(0, seg, src)
def _pad(x, pw):
    flat = tuple(v for pair in reversed(pw) for v in pair)
    return torch.nn.functional.pad(x, flat)

kernel_name = 'interleave_layers__linear_attn_block__glu_gated_geglu__prompt'

def setup_inputs():

    _w = (lambda a: (lambda t: t.to(torch.bfloat16) if t.is_floating_point() else t)(torch.as_tensor(a)))
    def _A_setup():
        B, S, D = 1, 2048, 512
        return {
            "x": _w((lambda *s: torch.randn(*s, dtype=torch.bfloat16) * 0.05)(B, S, D)),
            "wqkv": _w((lambda *s: torch.randn(*s, dtype=torch.bfloat16) * 0.05)(D, 3 * D)),
            "wo": _w((lambda *s: torch.randn(*s, dtype=torch.bfloat16) * 0.05)(D, D)),
        }
    _A_in = _A_setup()

    def _B_setup():
        B, S, Dm, Df = 1, 2048, 512, 1376
        return {
            "x": _w((lambda *s: torch.randn(*s, dtype=torch.bfloat16) * 0.05)(B, S, Dm)),
            "w_gate": _w((lambda *s: torch.randn(*s, dtype=torch.bfloat16) * 0.8)(Dm, Df) * (Dm ** -0.5)),
            "w_up": _w((lambda *s: torch.randn(*s, dtype=torch.bfloat16) * 0.8)(Dm, Df) * (Dm ** -0.5)),
            "w_down": _w((lambda *s: torch.randn(*s, dtype=torch.bfloat16) * 0.8)(Df, Dm) * (Df ** -0.5)),
        }
    _B_in = _B_setup()

    return {
        "A_x": _A_in["x"],
        "A_wqkv": _A_in["wqkv"],
        "A_wo": _A_in["wo"],
        "B_x": _B_in["x"],
        "B_w_gate": _B_in["w_gate"],
        "B_w_up": _B_in["w_up"],
        "B_w_down": _B_in["w_down"],
    }

def reference(A_x, A_wqkv, A_wo, B_x, B_w_gate, B_w_up, B_w_down):
    def _A_ref(x, wqkv, wo):
        B, S, D = x.shape
        H = 32; Dh = D // H
        qkv = (lambda x, *d: x.permute(*d))((x @ wqkv).reshape(B, S, 3, H, Dh), 2, 0, 3, 1, 4)
        q, k, v = qkv[0], qkv[1], qkv[2]
        phi = lambda t: torch.where(t > 0, t + 1, torch.exp(t)) + 1e-6
        pq, pk = phi(q), phi(k)
        kv = torch.einsum("bhsd,bhse->bhde", pk, v)
        z = torch.einsum("bhsd->bhd", pk)
        num = torch.einsum("bhqd,bhde->bhqe", pq, kv)
        den = torch.einsum("bhqd,bhd->bhq", pq, z)[..., None] + 1e-6
        o = num / den
        return (lambda x, *d: x.permute(*d))(o, 0, 2, 1, 3).reshape(B, S, D) @ wo

    def _B_ref(x, w_gate, w_up, w_down):
        g = torch.einsum("bsd,df->bsf", x, w_gate)
        u = torch.einsum("bsd,df->bsf", x, w_up)
        h = _gelu(g) * u
        return torch.einsum("bsf,fd->bsd", h, w_down)

    x = A_x
    x = x + _A_ref(_layernorm(x, axis=-1), A_wqkv, A_wo)
    x = x + _B_ref(_layernorm(x, axis=-1), B_w_gate, B_w_up, B_w_down)
    x = x + _A_ref(_layernorm(x, axis=-1), A_wqkv, A_wo)
    x = x + _B_ref(_layernorm(x, axis=-1), B_w_gate, B_w_up, B_w_down)
    return x
```

```asm
; @launch grid=(256,1,1) block=(512,1,1) lds=163840
.amdgcn_target "amdgcn-amd-amdhsa--gfx950"
.text
.globl interleave_layers__linear_attn_block__glu_gated_geglu__prompt_kernel
.p2align 8
.type interleave_layers__linear_attn_block__glu_gated_geglu__prompt_kernel,@function
interleave_layers__linear_attn_block__glu_gated_geglu__prompt_kernel:
    s_cmp_ge_u32 s2, 256
    s_cbranch_scc1 L_end
    s_load_dwordx16 s[64:79], s[0:1], 0
    s_load_dwordx4 s[80:83], s[0:1], 64
    v_lshrrev_b32 v8, 6, v0
    v_and_b32 v7, 63, v0
    v_readfirstlane_b32 s3, v8
    v_lshlrev_b32 v1, 4, v7
    v_lshlrev_b32 v6, 2, v7
    v_lshrrev_b32 v8, 5, v7
    v_lshlrev_b32 v8, 2, v8
    v_bfe_u32 v9, v7, 2, 2
    v_add_u32 v8, v8, v9
    v_lshlrev_b32 v8, 6, v8
    v_bfe_u32 v9, v7, 4, 1
    v_lshl_add_u32 v8, v9, 5, v8
    v_and_b32 v9, 3, v7
    v_lshl_add_u32 v2, v9, 3, v8
    s_and_b32 s24, s2, 7
    s_lshr_b32 s25, s2, 3
    s_lshr_b32 s26, s25, 4
    s_lshl_b32 s16, s24, 1
    s_add_u32 s16, s16, s26
    s_and_b32 s17, s25, 15
    s_mov_b32 s49, 0
    s_waitcnt lgkmcnt(0)
    s_mov_b32 s4, s82
    s_and_b32 s5, s83, 0xffff
    s_mov_b32 s6, 268435456
    s_mov_b32 s7, 0x00020000
    s_cmp_ge_u32 s3, 4
    s_cbranch_scc1 L_helper
    s_setprio 2
    s_mov_b32 s18, s3
    s_mov_b32 s12, s64
    s_and_b32 s13, s65, 0xffff
    s_mov_b32 s14, 2097152
    s_mov_b32 s15, 0x00020000
    s_mul_i32 s21, s16, 524288
    s_add_u32 s44, s21, 499712
    v_and_b32 v8, 7, v7
    v_lshrrev_b32 v9, 3, v7
    v_lshlrev_b32 v10, 10, v8
    v_lshl_add_u32 v10, v9, 5, v10
    s_lshl_b32 s24, s16, 17
    s_lshl_b32 s25, s17, 13
    s_add_u32 s24, s24, s25
    s_lshl_b32 s25, s18, 8
    s_add_u32 s24, s24, s25
    buffer_load_dwordx4 v[104:107], v10, s[12:15], s24 offen
    buffer_load_dwordx4 v[108:111], v10, s[12:15], s24 offen offset:16
    s_add_u32 s29, s44, 640
    s_load_dword s57, s[82:83], s29
    s_cmp_lg_u32 s18, 0
    s_cbranch_scc1 Lta1
    s_add_u32 s30, s44, 256
    v_mov_b32 v54, 0
    s_mov_b64 exec, 1
    buffer_load_dword v55, v54, s[4:7], s30 offen
    s_mov_b64 exec, -1
Lta1:
    s_mov_b32 s8, s78
    s_and_b32 s9, s79, 0xffff
    s_mov_b32 s10, 2097152
    s_mov_b32 s11, 0x00020000
    s_mov_b32 s40, 0x358637bd
    s_mov_b32 s42, 0x3fb8aa3b
    s_mov_b32 s41, 0xffff0000
    s_mov_b32 s43, 0x3f803f80
    s_mov_b32 s23, 0
    s_lshl_b32 s51, s17, 4
    s_lshl_b32 s29, s18, 2
    s_add_u32 s51, s51, s29
    s_add_u32 s51, s51, s44
    s_lshr_b32 s47, s18, 1
    s_and_b32 s29, s18, 1
    s_lshr_b32 s45, s17, 3
    s_lshl_b32 s45, s45, 1
    s_add_u32 s45, s45, s29
    s_and_b32 s46, s17, 7
    s_lshl_b32 s29, s47, 11
    v_add_u32 v3, s29, v2
    s_lshl_b32 s55, s45, 15
    s_lshl_b32 s29, s46, 12
    s_add_u32 s55, s55, s29
    s_lshl_b32 s29, s47, 11
    s_add_u32 s55, s55, s29
    s_lshr_b32 s24, s17, 2
    s_lshl_b32 s25, s24, 15
    s_lshl_b32 s26, s18, 13
    s_add_u32 s25, s25, s26
    s_and_b32 s26, s17, 3
    s_lshl_b32 s26, s26, 7
    s_add_u32 s25, s25, s26
    s_add_u32 s25, s25, s21
    v_lshlrev_b32 v11, 4, v8
    v_lshl_add_u32 v11, v9, 10, v11
    s_lshl_b32 s27, s24, 12
    s_lshl_b32 s28, s18, 10
    s_add_u32 s27, s27, s28
    s_lshr_b32 s26, s26, 1
    s_add_u32 s27, s27, s26
    s_add_u32 s27, s27, s21
    s_add_u32 s27, s27, 131072
    v_lshrrev_b32 v12, 1, v9
    v_lshlrev_b32 v12, 8, v12
    v_lshl_add_u32 v12, v8, 3, v12
    v_mov_b32 v48, 0
    v_mov_b32 v49, 0
    v_mov_b32 v50, s43
    s_waitcnt vmcnt(0)
    v_dot2c_f32_bf16 v48, v104, v50
    v_dot2c_f32_bf16 v49, v104, v104
    v_dot2c_f32_bf16 v48, v105, v50
    v_dot2c_f32_bf16 v49, v105, v105
    v_dot2c_f32_bf16 v48, v106, v50
    v_dot2c_f32_bf16 v49, v106, v106
    v_dot2c_f32_bf16 v48, v107, v50
    v_dot2c_f32_bf16 v49, v107, v107
    v_dot2c_f32_bf16 v48, v108, v50
    v_dot2c_f32_bf16 v49, v108, v108
    v_dot2c_f32_bf16 v48, v109, v50
    v_dot2c_f32_bf16 v49, v109, v109
    v_dot2c_f32_bf16 v48, v110, v50
    v_dot2c_f32_bf16 v49, v110, v110
    v_dot2c_f32_bf16 v48, v111, v50
    v_dot2c_f32_bf16 v49, v111, v111
    v_swap_b32 v106, v108
    v_swap_b32 v107, v109
    buffer_store_dwordx4 v[104:107], v11, s[4:7], s25 offen
    buffer_store_dwordx4 v[108:111], v11, s[4:7], s25 offen offset:512
    v_add_f32_dpp v48, v48, v48 row_ror:8 row_mask:0xf bank_mask:0xf
    v_add_f32_dpp v49, v49, v49 row_ror:8 row_mask:0xf bank_mask:0xf
    buffer_store_dwordx2 v[48:49], v12, s[4:7], s27 offen
    s_waitcnt vmcnt(0) lgkmcnt(0)
    s_mul_i32 s20, s57, 0x9e3779b1
    s_add_u32 s20, s20, 0x6a09e667
    s_barrier
    s_cmp_lg_u32 s18, 0
    s_cbranch_scc1 Lm2
    s_getreg_b32 s26, hwreg(HW_REG_XCC_ID, 0, 4)
    s_add_u32 s27, s20, 16
    s_add_u32 s28, s27, s26
    s_lshl_b32 s29, s17, 2
    s_add_u32 s29, s29, s44
    s_add_u32 s29, s29, 256
    s_add_u32 s24, s44, 256
    v_mov_b32 v11, 0
    v_mov_b32 v12, s28
    s_mov_b64 exec, 1
    buffer_store_dword v12, v11, s[4:7], s29 offen
    s_mov_b64 exec, -1
    v_and_b32 v8, 15, v7
    v_lshlrev_b32 v8, 2, v8
    v_bfe_u32 v9, v7, 4, 1
    v_lshl_add_u32 v8, v9, 7, v8
    s_mov_b32 s48, 0
Lfp3:
    buffer_load_dword v9, v8, s[4:7], s24 offen sc1
    s_waitcnt vmcnt(0)
    v_subrev_u32 v9, s27, v9
    v_cmp_gt_u32 vcc, 32, v9
    s_nop 1
    s_and_b32 s30, vcc_lo, 0xffff
    s_cmp_eq_u32 s30, 0xffff
    s_cbranch_scc1 Lfd4
    s_lshr_b32 s30, vcc_lo, 16
    s_cmp_eq_u32 s30, 0xffff
    s_cbranch_scc1 Lfq5
    s_add_u32 s48, s48, 1
    s_cmp_lt_u32 s48, 400000
    s_cbranch_scc1 Lfp3
    s_mov_b32 s49, 1
    s_branch Lfd4
Lfq5:
    v_and_b32 v9, 15, v9
    v_cmp_eq_u32 vcc, s26, v9
    s_nop 1
    s_lshr_b32 s30, vcc_lo, 16
    s_branch Lfr6
Lfd4:
    v_and_b32 v9, 15, v9
    v_cmp_eq_u32 vcc, s26, v9
    s_nop 1
    s_and_b32 s30, vcc_lo, 0xffff
Lfr6:
    s_cmp_eq_u32 s30, 0xffff
    s_cselect_b32 s19, 0, 1
    s_add_u32 s29, s29, 256
    s_add_u32 s24, s24, 256
    v_and_b32 v8, 15, v7
    v_lshlrev_b32 v8, 2, v8
    s_cmp_lg_u32 s19, 0
    s_cbranch_scc1 Lsl7
Lsb8:
    v_mov_b32 v8, 157184
    v_mov_b32 v9, s19
    ds_write_b32 v8, v9
Lm2:
    s_waitcnt lgkmcnt(0)
    s_barrier
    v_mov_b32 v8, 157184
    ds_read_b32 v9, v8
    s_waitcnt lgkmcnt(0)
    v_readfirstlane_b32 s19, v9
    s_nop 3
    s_cmp_lg_u32 s19, 0
    s_cbranch_scc1 Liv11
Lik12:
L_layer:
    s_add_u32 s50, s21, 0
    s_lshl_b32 s54, s18, 15
    s_add_u32 s54, s54, s21
    s_mov_b32 s26, s54
    buffer_load_dwordx4 v[128:131], v1, s[4:7], s26 offen offset:0 sc1
    buffer_load_dwordx4 v[132:135], v1, s[4:7], s26 offen offset:1024 sc1
    v_add_u32 v4, 32768, v2
    v_add_u32 v5, 49152, v2
    s_barrier
    ds_read_b64_tr_b16 v[16:17], v4 offset:0
    ds_read_b64_tr_b16 v[18:19], v4 offset:512
    ds_read_b64_tr_b16 v[20:21], v4 offset:1024
    ds_read_b64_tr_b16 v[22:23], v4 offset:1536
    ds_read_b64_tr_b16 v[24:25], v4 offset:2048
    ds_read_b64_tr_b16 v[26:27], v4 offset:2560
    ds_read_b64_tr_b16 v[28:29], v4 offset:3072
    ds_read_b64_tr_b16 v[30:31], v4 offset:3584
    buffer_load_dwordx4 v[136:139], v1, s[4:7], s26 offen offset:2048 sc1
    buffer_load_dwordx4 v[140:143], v1, s[4:7], s26 offen offset:3072 sc1
    s_add_u32 s26, s54, 4096
    buffer_load_dwordx4 v[144:147], v1, s[4:7], s26 offen offset:0 sc1
    buffer_load_dwordx4 v[148:151], v1, s[4:7], s26 offen offset:1024 sc1
    buffer_load_dwordx4 v[152:155], v1, s[4:7], s26 offen offset:2048 sc1
    buffer_load_dwordx4 v[156:159], v1, s[4:7], s26 offen offset:3072 sc1
    s_add_u32 s26, s54, 8192
    buffer_load_dwordx4 v[160:163], v1, s[4:7], s26 offen offset:0 sc1
    buffer_load_dwordx4 v[164:167], v1, s[4:7], s26 offen offset:1024 sc1
    buffer_load_dwordx4 v[168:171], v1, s[4:7], s26 offen offset:2048 sc1
    ds_read_b64_tr_b16 v[32:33], v4 offset:4096
    ds_read_b64_tr_b16 v[34:35], v4 offset:4608
    s_waitcnt vmcnt(10) lgkmcnt(6)
    v_mfma_f32_32x32x16_bf16 v[40:55], v[128:131], v[16:19], 0
    s_lshl_b32 s27, s18, 12
    s_add_u32 s27, s27, s21
    ds_read_b64_tr_b16 v[36:37], v4 offset:5120
    ds_read_b64_tr_b16 v[38:39], v4 offset:5632
    v_mfma_f32_32x32x16_bf16 v[56:71], v[128:131], v[20:23], 0
    s_add_u32 s27, s27, 131072
    buffer_load_dwordx4 v[172:175], v1, s[4:7], s26 offen offset:3072 sc1
    ds_read_b64_tr_b16 v[16:17], v4 offset:6144
    ds_read_b64_tr_b16 v[18:19], v4 offset:6656
    s_waitcnt vmcnt(10) lgkmcnt(6)
    v_mfma_f32_32x32x16_bf16 v[40:55], v[132:135], v[24:27], v[40:55]
    buffer_load_dwordx4 v[104:107], v1, s[4:7], s27 offen offset:0 sc1
    ds_read_b64_tr_b16 v[20:21], v4 offset:7168
    ds_read_b64_tr_b16 v[22:23], v4 offset:7680
    v_mfma_f32_32x32x16_bf16 v[56:71], v[132:135], v[28:31], v[56:71]
    buffer_load_dwordx4 v[108:111], v1, s[4:7], s27 offen offset:1024 sc1
    s_add_u32 s26, s54, 12288
    buffer_load_dwordx4 v[176:179], v1, s[4:7], s26 offen offset:0 sc1
    ds_read_b64_tr_b16 v[24:25], v4 offset:8192
    ds_read_b64_tr_b16 v[26:27], v4 offset:8704
    s_waitcnt vmcnt(12) lgkmcnt(6)
    v_mfma_f32_32x32x16_bf16 v[40:55], v[136:139], v[32:35], v[40:55]
    buffer_load_dwordx4 v[112:115], v1, s[4:7], s27 offen offset:2048 sc1
    ds_read_b64_tr_b16 v[28:29], v4 offset:9216
    ds_read_b64_tr_b16 v[30:31], v4 offset:9728
    v_mfma_f32_32x32x16_bf16 v[56:71], v[136:139], v[36:39], v[56:71]
    buffer_load_dwordx4 v[116:119], v1, s[4:7], s27 offen offset:3072 sc1
    buffer_load_dwordx4 v[180:183], v1, s[4:7], s26 offen offset:1024 sc1
    ds_read_b64_tr_b16 v[32:33], v4 offset:10240
    ds_read_b64_tr_b16 v[34:35], v4 offset:10752
    s_waitcnt vmcnt(14) lgkmcnt(6)
    v_mfma_f32_32x32x16_bf16 v[40:55], v[140:143], v[16:19], v[40:55]
    ds_read_b64_tr_b16 v[36:37], v4 offset:11264
    ds_read_b64_tr_b16 v[38:39], v4 offset:11776
    v_mfma_f32_32x32x16_bf16 v[56:71], v[140:143], v[20:23], v[56:71]
    buffer_load_dwordx4 v[184:187], v1, s[4:7], s26 offen offset:2048 sc1
    ds_read_b64_tr_b16 v[16:17], v4 offset:12288
    ds_read_b64_tr_b16 v[18:19], v4 offset:12800
    s_waitcnt vmcnt(14) lgkmcnt(6)
    v_mfma_f32_32x32x16_bf16 v[40:55], v[144:147], v[24:27], v[40:55]
    ds_read_b64_tr_b16 v[20:21], v4 offset:13312
    ds_read_b64_tr_b16 v[22:23], v4 offset:13824
    v_mfma_f32_32x32x16_bf16 v[56:71], v[144:147], v[28:31], v[56:71]
    buffer_load_dwordx4 v[188:191], v1, s[4:7], s26 offen offset:3072 sc1
    ds_read_b64_tr_b16 v[24:25], v4 offset:14336
    ds_read_b64_tr_b16 v[26:27], v4 offset:14848
    s_waitcnt vmcnt(14) lgkmcnt(6)
    v_mfma_f32_32x32x16_bf16 v[40:55], v[148:151], v[32:35], v[40:55]
    ds_read_b64_tr_b16 v[28:29], v4 offset:15360
    ds_read_b64_tr_b16 v[30:31], v4 offset:15872
    v_mfma_f32_32x32x16_bf16 v[56:71], v[148:151], v[36:39], v[56:71]
    s_add_u32 s26, s54, 16384
    buffer_load_dwordx4 v[192:195], v1, s[4:7], s26 offen offset:0 sc1
    ds_read_b64_tr_b16 v[32:33], v5 offset:0
    ds_read_b64_tr_b16 v[34:35], v5 offset:512
    s_waitcnt vmcnt(14) lgkmcnt(6)
    v_mfma_f32_32x32x16_bf16 v[40:55], v[152:155], v[16:19], v[40:55]
    ds_read_b64_tr_b16 v[36:37], v5 offset:1024
    ds_read_b64_tr_b16 v[38:39], v5 offset:1536
    v_mfma_f32_32x32x16_bf16 v[56:71], v[152:155], v[20:23], v[56:71]
    buffer_load_dwordx4 v[196:199], v1, s[4:7], s26 offen offset:1024 sc1
    ds_read_b64_tr_b16 v[16:17], v5 offset:2048
    ds_read_b64_tr_b16 v[18:19], v5 offset:2560
    s_waitcnt vmcnt(14) lgkmcnt(6)
    v_mfma_f32_32x32x16_bf16 v[40:55], v[156:159], v[24:27], v[40:55]
    ds_read_b64_tr_b16 v[20:21], v5 offset:3072
    ds_read_b64_tr_b16 v[22:23], v5 offset:3584
    v_mfma_f32_32x32x16_bf16 v[56:71], v[156:159], v[28:31], v[56:71]
    s_barrier
    v_add_u32 v4, 65536, v2
    buffer_load_dwordx4 v[200:203], v1, s[4:7], s26 offen offset:2048 sc1
    ds_read_b64_tr_b16 v[24:25], v5 offset:4096
    ds_read_b64_tr_b16 v[26:27], v5 offset:4608
    s_waitcnt vmcnt(14) lgkmcnt(6)
    v_mfma_f32_32x32x16_bf16 v[40:55], v[160:163], v[32:35], v[40:55]
    ds_read_b64_tr_b16 v[28:29], v5 offset:5120
    ds_read_b64_tr_b16 v[30:31], v5 offset:5632
    v_mfma_f32_32x32x16_bf16 v[56:71], v[160:163], v[36:39], v[56:71]
    buffer_load_dwordx4 v[204:207], v1, s[4:7], s26 offen offset:3072 sc1
    ds_read_b64_tr_b16 v[32:33], v5 offset:6144
    ds_read_b64_tr_b16 v[34:35], v5 offset:6656
    s_waitcnt vmcnt(14) lgkmcnt(6)
    v_mfma_f32_32x32x16_bf16 v[40:55], v[164:167], v[16:19], v[40:55]
    s_waitcnt vmcnt(7)
    v_add_f32 v104, v104, v108
    v_add_f32 v105, v105, v109
    ds_read_b64_tr_b16 v[36:37], v5 offset:7168
    ds_read_b64_tr_b16 v[38:39], v5 offset:7680
    v_mfma_f32_32x32x16_bf16 v[56:71], v[164:167], v[20:23], v[56:71]
    v_add_f32 v106, v106, v110
    v_add_f32 v107, v107, v111
    v_add_f32 v112, v112, v116
    s_add_u32 s26, s54, 20480
    buffer_load_dwordx4 v[208:211], v1, s[4:7], s26 offen offset:0 sc1
    ds_read_b64_tr_b16 v[16:17], v5 offset:8192
    ds_read_b64_tr_b16 v[18:19], v5 offset:8704
    s_waitcnt lgkmcnt(6)
    v_mfma_f32_32x32x16_bf16 v[40:55], v[168:171], v[24:27], v[40:55]
    v_add_f32 v113, v113, v117
    v_add_f32 v114, v114, v118
    v_add_f32 v115, v115, v119
    ds_read_b64_tr_b16 v[20:21], v5 offset:9216
    ds_read_b64_tr_b16 v[22:23], v5 offset:9728
    v_mfma_f32_32x32x16_bf16 v[56:71], v[168:171], v[28:31], v[56:71]
    v_add_f32 v104, v104, v112
    v_add_f32 v105, v105, v113
    v_add_f32 v106, v106, v114
    buffer_load_dwordx4 v[212:215], v1, s[4:7], s26 offen offset:1024 sc1
    ds_read_b64_tr_b16 v[24:25], v5 offset:10240
    ds_read_b64_tr_b16 v[26:27], v5 offset:10752
    s_waitcnt lgkmcnt(6)
    v_mfma_f32_32x32x16_bf16 v[40:55], v[172:175], v[32:35], v[40:55]
    v_add_f32 v107, v107, v115
    v_and_b32 v112, 31, v7
    ds_read_b64_tr_b16 v[28:29], v5 offset:11264
    ds_read_b64_tr_b16 v[30:31], v5 offset:11776
    v_mfma_f32_32x32x16_bf16 v[56:71], v[172:175], v[36:39], v[56:71]
    v_and_b32 v113, 1, v7
    v_permlane16_swap_b32 v104, v106
    buffer_load_dwordx4 v[216:219], v1, s[4:7], s26 offen offset:2048 sc1
    ds_read_b64_tr_b16 v[32:33], v5 offset:12288
    ds_read_b64_tr_b16 v[34:35], v5 offset:12800
    s_waitcnt lgkmcnt(6)
    v_mfma_f32_32x32x16_bf16 v[40:55], v[176:179], v[16:19], v[40:55]
    v_permlane16_swap_b32 v105, v107
    v_lshrrev_b32 v112, 1, v112
    ds_read_b64_tr_b16 v[36:37], v5 offset:13312
    ds_read_b64_tr_b16 v[38:39], v5 offset:13824
    v_mfma_f32_32x32x16_bf16 v[56:71], v[176:179], v[20:23], v[56:71]
    v_lshl_add_u32 v112, v113, 4, v112
    v_add_f32 v104, v104, v106
    buffer_load_dwordx4 v[220:223], v1, s[4:7], s26 offen offset:3072 sc1
    ds_read_b64_tr_b16 v[16:17], v5 offset:14336
    ds_read_b64_tr_b16 v[18:19], v5 offset:14848
    s_waitcnt vmcnt(10) lgkmcnt(6)
    v_mfma_f32_32x32x16_bf16 v[40:55], v[180:183], v[24:27], v[40:55]
    v_add_f32 v105, v105, v107
    v_lshlrev_b32 v112, 2, v112
    ds_read_b64_tr_b16 v[20:21], v5 offset:15360
    ds_read_b64_tr_b16 v[22:23], v5 offset:15872
    v_mfma_f32_32x32x16_bf16 v[56:71], v[180:183], v[28:31], v[56:71]
    v_mov_b32 v106, v104
    v_mov_b32 v107, v105
    s_add_u32 s26, s54, 24576
    buffer_load_dwordx4 v[224:227], v1, s[4:7], s26 offen offset:0 sc1
    ds_read_b64_tr_b16 v[24:25], v4 offset:0
    ds_read_b64_tr_b16 v[26:27], v4 offset:512
    s_waitcnt vmcnt(10) lgkmcnt(6)
    v_mfma_f32_32x32x16_bf16 v[40:55], v[184:187], v[32:35], v[40:55]
    v_permlane32_swap_b32 v104, v106
    v_permlane32_swap_b32 v105, v107
    ds_read_b64_tr_b16 v[28:29], v4 offset:1024
    ds_read_b64_tr_b16 v[30:31], v4 offset:1536
    v_mfma_f32_32x32x16_bf16 v[56:71], v[184:187], v[36:39], v[56:71]
    v_add_f32 v106, v104, v106
    v_add_f32 v107, v105, v107
    buffer_load_dwordx4 v[228:231], v1, s[4:7], s26 offen offset:1024 sc1
    ds_read_b64_tr_b16 v[32:33], v4 offset:2048
    ds_read_b64_tr_b16 v[34:35], v4 offset:2560
    s_waitcnt vmcnt(10) lgkmcnt(6)
    v_mfma_f32_32x32x16_bf16 v[40:55], v[188:191], v[16:19], v[40:55]
    ds_bpermute_b32 v104, v112, v106
    ds_bpermute_b32 v105, v112, v107
    ds_read_b64_tr_b16 v[36:37], v4 offset:3072
    ds_read_b64_tr_b16 v[38:39], v4 offset:3584
    v_mfma_f32_32x32x16_bf16 v[56:71], v[188:191], v[20:23], v[56:71]
    s_waitcnt lgkmcnt(2)
    v_mul_f32 v104, 0xbb000000, v104
    s_barrier
    v_add_u32 v5, 81920, v2
    buffer_load_dwordx4 v[232:235], v1, s[4:7], s26 offen offset:2048 sc1
    ds_read_b64_tr_b16 v[16:17], v4 offset:4096
    ds_read_b64_tr_b16 v[18:19], v4 offset:4608
    s_waitcnt vmcnt(10)
    v_mfma_f32_32x32x16_bf16 v[40:55], v[192:195], v[24:27], v[40:55]
    v_mul_f32 v105, 0x3b000000, v105
    v_fma_f32 v105, -v104, v104, v105
    ds_read_b64_tr_b16 v[20:21], v4 offset:5120
    ds_read_b64_tr_b16 v[22:23], v4 offset:5632
    v_mfma_f32_32x32x16_bf16 v[56:71], v[192:195], v[28:31], v[56:71]
    v_max_f32 v105, 0, v105
    v_add_f32 v121, 0x3727c5ac, v105
    buffer_load_dwordx4 v[236:239], v1, s[4:7], s26 offen offset:3072 sc1
    ds_read_b64_tr_b16 v[24:25], v4 offset:6144
    ds_read_b64_tr_b16 v[26:27], v4 offset:6656
    s_waitcnt vmcnt(10) lgkmcnt(6)
    v_mfma_f32_32x32x16_bf16 v[40:55], v[196:199], v[32:35], v[40:55]
    v_rsq_f32 v120, v121
    v_and_b32 v106, s41, v104
    ds_read_b64_tr_b16 v[28:29], v4 offset:7168
    ds_read_b64_tr_b16 v[30:31], v4 offset:7680
    v_mfma_f32_32x32x16_bf16 v[56:71], v[196:199], v[36:39], v[56:71]
    v_sub_f32 v107, v104, v106
    v_lshrrev_b32 v106, 16, v106
    s_add_u32 s26, s54, 28672
    buffer_load_dwordx4 v[240:243], v1, s[4:7], s26 offen offset:0 sc1
    ds_read_b64_tr_b16 v[32:33], v4 offset:8192
    ds_read_b64_tr_b16 v[34:35], v4 offset:8704
    s_waitcnt vmcnt(10) lgkmcnt(6)
    v_mfma_f32_32x32x16_bf16 v[40:55], v[200:203], v[16:19], v[40:55]
    v_and_or_b32 v106, v107, s41, v106
    v_cmp_gt_u32 vcc, 32, v7
    ds_read_b64_tr_b16 v[36:37], v4 offset:9216
    ds_read_b64_tr_b16 v[38:39], v4 offset:9728
    v_mfma_f32_32x32x16_bf16 v[56:71], v[200:203], v[20:23], v[56:71]
    v_mov_b32 v126, 0
    v_mov_b32 v127, 0
    buffer_load_dwordx4 v[244:247], v1, s[4:7], s26 offen offset:1024 sc1
    ds_read_b64_tr_b16 v[16:17], v4 offset:10240
    ds_read_b64_tr_b16 v[18:19], v4 offset:10752
    s_waitcnt vmcnt(10) lgkmcnt(6)
    v_mfma_f32_32x32x16_bf16 v[40:55], v[204:207], v[24:27], v[40:55]
    v_cndmask_b32 v124, 0, v106, vcc
    v_mov_b32 v125, v124
    ds_read_b64_tr_b16 v[20:21], v4 offset:11264
    ds_read_b64_tr_b16 v[22:23], v4 offset:11776
    v_mfma_f32_32x32x16_bf16 v[56:71], v[204:207], v[28:31], v[56:71]
    s_lshl_b32 s28, s18, 7
    s_add_u32 s28, s28, 152064
    buffer_load_dwordx4 v[248:251], v1, s[4:7], s26 offen offset:2048 sc1
    ds_read_b64_tr_b16 v[24:25], v4 offset:12288
    ds_read_b64_tr_b16 v[26:27], v4 offset:12800
    s_waitcnt vmcnt(10) lgkmcnt(6)
    v_mfma_f32_32x32x16_bf16 v[40:55], v[208:211], v[32:35], v[40:55]
    v_and_b32 v8, 31, v7
    v_lshlrev_b32 v8, 2, v8
    ds_read_b64_tr_b16 v[28:29], v4 offset:13312
    ds_read_b64_tr_b16 v[30:31], v4 offset:13824
    v_mfma_f32_32x32x16_bf16 v[56:71], v[208:211], v[36:39], v[56:71]
    v_add_u32 v8, s28, v8
    ds_write_b32 v8, v120
    buffer_load_dwordx4 v[252:255], v1, s[4:7], s26 offen offset:3072 sc1
    ds_read_b64_tr_b16 v[32:33], v4 offset:14336
    ds_read_b64_tr_b16 v[34:35], v4 offset:14848
    s_waitcnt vmcnt(10) lgkmcnt(7)
    v_mfma_f32_32x32x16_bf16 v[40:55], v[212:215], v[16:19], v[40:55]
    v_lshrrev_b32 v9, 5, v7
    v_lshlrev_b32 v9, 4, v9
    ds_read_b64_tr_b16 v[36:37], v4 offset:15360
    ds_read_b64_tr_b16 v[38:39], v4 offset:15872
    v_mfma_f32_32x32x16_bf16 v[56:71], v[212:215], v[20:23], v[56:71]
    v_add_u32 v9, s28, v9
    s_waitcnt lgkmcnt(4)
    ds_read_b64_tr_b16 v[16:17], v5 offset:0
    ds_read_b64_tr_b16 v[18:19], v5 offset:512
    s_waitcnt vmcnt(9)
    v_mfma_f32_32x32x16_bf16 v[40:55], v[216:219], v[24:27], v[40:55]
    ds_read_b128 v[104:107], v9 offset:0
    ds_read_b128 v[108:111], v9 offset:32
    ds_read_b64_tr_b16 v[20:21], v5 offset:1024
    ds_read_b64_tr_b16 v[22:23], v5 offset:1536
    v_mfma_f32_32x32x16_bf16 v[56:71], v[216:219], v[28:31], v[56:71]
    ds_read_b128 v[112:115], v9 offset:64
    ds_read_b128 v[116:119], v9 offset:96
    ds_read_b64_tr_b16 v[24:25], v5 offset:2048
    ds_read_b64_tr_b16 v[26:27], v5 offset:2560
    s_waitcnt vmcnt(8) lgkmcnt(10)
    v_mfma_f32_32x32x16_bf16 v[40:55], v[220:223], v[32:35], v[40:55]
    ds_read_b64_tr_b16 v[28:29], v5 offset:3072
    ds_read_b64_tr_b16 v[30:31], v5 offset:3584
    v_mfma_f32_32x32x16_bf16 v[56:71], v[220:223], v[36:39], v[56:71]
    s_barrier
    ds_read_b64_tr_b16 v[32:33], v5 offset:4096
    ds_read_b64_tr_b16 v[34:35], v5 offset:4608
    s_waitcnt vmcnt(7) lgkmcnt(8)
    v_mfma_f32_32x32x16_bf16 v[40:55], v[224:227], v[16:19], v[40:55]
    v_and_b32 v10, 31, v7
    v_lshlrev_b32 v10, 4, v10
    v_add_u32 v10, 147456, v10
    ds_read_b64_tr_b16 v[36:37], v5 offset:5120
    ds_read_b64_tr_b16 v[38:39], v5 offset:5632
    v_mfma_f32_32x32x16_bf16 v[56:71], v[224:227], v[20:23], v[56:71]
    ds_read_b128 v[96:99], v10
    s_waitcnt lgkmcnt(0)
    v_add_f32 v96, v96, v97
    ds_read_b64_tr_b16 v[16:17], v5 offset:6144
    ds_read_b64_tr_b16 v[18:19], v5 offset:6656
    s_waitcnt vmcnt(6)
    v_mfma_f32_32x32x16_bf16 v[40:55], v[228:231], v[24:27], v[40:55]
    v_add_f32 v98, v98, v99
    v_add_f32 v99, v96, v98
    ds_read_b64_tr_b16 v[20:21], v5 offset:7168
    ds_read_b64_tr_b16 v[22:23], v5 offset:7680
    v_mfma_f32_32x32x16_bf16 v[56:71], v[228:231], v[28:31], v[56:71]
    v_and_b32 v10, s41, v99
    v_sub_f32 v99, v99, v10
    ds_read_b64_tr_b16 v[24:25], v5 offset:8192
    ds_read_b64_tr_b16 v[26:27], v5 offset:8704
    s_waitcnt vmcnt(5)
    v_mfma_f32_32x32x16_bf16 v[40:55], v[232:235], v[32:35], v[40:55]
    v_lshrrev_b32 v96, 16, v10
    v_and_b32 v98, s41, v99
    ds_read_b64_tr_b16 v[28:29], v5 offset:9216
    ds_read_b64_tr_b16 v[30:31], v5 offset:9728
    v_mfma_f32_32x32x16_bf16 v[56:71], v[232:235], v[36:39], v[56:71]
    v_or_b32 v96, v96, v10
    v_lshrrev_b32 v97, 16, v98
    ds_read_b64_tr_b16 v[32:33], v5 offset:10240
    ds_read_b64_tr_b16 v[34:35], v5 offset:10752
    s_waitcnt vmcnt(4) lgkmcnt(6)
    v_mfma_f32_32x32x16_bf16 v[40:55], v[236:239], v[16:19], v[40:55]
    v_or_b32 v97, v97, v98
    v_and_b32 v10, 31, v7
    ds_read_b64_tr_b16 v[36:37], v5 offset:11264
    ds_read_b64_tr_b16 v[38:39], v5 offset:11776
    v_mfma_f32_32x32x16_bf16 v[56:71], v[236:239], v[20:23], v[56:71]
    v_lshlrev_b32 v10, 4, v10
    v_add_u32 v10, 147968, v10
    ds_read_b64_tr_b16 v[16:17], v5 offset:12288
    ds_read_b64_tr_b16 v[18:19], v5 offset:12800
    s_waitcnt vmcnt(3) lgkmcnt(6)
    v_mfma_f32_32x32x16_bf16 v[40:55], v[240:243], v[24:27], v[40:55]
    ds_read_b128 v[100:103], v10
    s_waitcnt lgkmcnt(0)
    ds_read_b64_tr_b16 v[20:21], v5 offset:13312
    ds_read_b64_tr_b16 v[22:23], v5 offset:13824
    v_mfma_f32_32x32x16_bf16 v[56:71], v[240:243], v[28:31], v[56:71]
    v_add_f32 v100, v100, v101
    v_add_f32 v102, v102, v103
    ds_read_b64_tr_b16 v[24:25], v5 offset:14336
    ds_read_b64_tr_b16 v[26:27], v5 offset:14848
    s_waitcnt vmcnt(2)
    v_mfma_f32_32x32x16_bf16 v[40:55], v[244:247], v[32:35], v[40:55]
    v_add_f32 v103, v100, v102
    v_and_b32 v10, s41, v103
    ds_read_b64_tr_b16 v[28:29], v5 offset:15360
    ds_read_b64_tr_b16 v[30:31], v5 offset:15872
    v_mfma_f32_32x32x16_bf16 v[56:71], v[244:247], v[36:39], v[56:71]
    v_sub_f32 v103, v103, v10
    v_lshrrev_b32 v100, 16, v10
    s_waitcnt vmcnt(1) lgkmcnt(4)
    v_mfma_f32_32x32x16_bf16 v[40:55], v[248:251], v[16:19], v[40:55]
    v_and_b32 v102, s41, v103
    v_or_b32 v100, v100, v10
    v_mfma_f32_32x32x16_bf16 v[56:71], v[248:251], v[20:23], v[56:71]
    v_lshrrev_b32 v101, 16, v102
    v_or_b32 v101, v101, v102
    s_waitcnt vmcnt(0) lgkmcnt(0)
    v_mfma_f32_32x32x16_bf16 v[40:55], v[252:255], v[24:27], v[40:55]
    v_mfma_f32_32x32x16_bf16 v[56:71], v[252:255], v[28:31], v[56:71]
    v_mfma_f32_32x32x16_bf16 v[40:55], v[124:127], v[96:99], v[40:55]
    v_mfma_f32_32x32x16_bf16 v[56:71], v[124:127], v[100:103], v[56:71]
    s_nop 10
    v_pk_fma_f32 v[40:41], v[40:41], v[104:105], s[40:41] op_sel_hi:[1,1,0]
    v_pk_fma_f32 v[42:43], v[42:43], v[106:107], s[40:41] op_sel_hi:[1,1,0]
    v_pk_fma_f32 v[44:45], v[44:45], v[108:109], s[40:41] op_sel_hi:[1,1,0]
    v_pk_fma_f32 v[46:47], v[46:47], v[110:111], s[40:41] op_sel_hi:[1,1,0]
    v_pk_fma_f32 v[48:49], v[48:49], v[112:113], s[40:41] op_sel_hi:[1,1,0]
    v_pk_fma_f32 v[50:51], v[50:51], v[114:115], s[40:41] op_sel_hi:[1,1,0]
    v_pk_fma_f32 v[52:53], v[52:53], v[116:117], s[40:41] op_sel_hi:[1,1,0]
    v_pk_fma_f32 v[54:55], v[54:55], v[118:119], s[40:41] op_sel_hi:[1,1,0]
    v_pk_mul_f32 v[16:17], v[40:41], s[42:43] op_sel_hi:[1,0]
    v_pk_mul_f32 v[18:19], v[42:43], s[42:43] op_sel_hi:[1,0]
    v_pk_mul_f32 v[20:21], v[44:45], s[42:43] op_sel_hi:[1,0]
    v_pk_mul_f32 v[22:23], v[46:47], s[42:43] op_sel_hi:[1,0]
    v_exp_f32 v16, v16 clamp
    v_exp_f32 v17, v17 clamp
    v_exp_f32 v18, v18 clamp
    v_exp_f32 v19, v19 clamp
    v_exp_f32 v20, v20 clamp
    v_exp_f32 v21, v21 clamp
    v_exp_f32 v22, v22 clamp
    v_exp_f32 v23, v23 clamp
    v_max_f32 v40, s40, v40
    v_max_f32 v41, s40, v41
    v_max_f32 v42, s40, v42
    v_max_f32 v43, s40, v43
    v_max_f32 v44, s40, v44
    v_max_f32 v45, s40, v45
    v_max_f32 v46, s40, v46
    v_max_f32 v47, s40, v47
    v_pk_add_f32 v[40:41], v[40:41], v[16:17]
    v_pk_add_f32 v[42:43], v[42:43], v[18:19]
    v_pk_add_f32 v[44:45], v[44:45], v[20:21]
    v_pk_add_f32 v[46:47], v[46:47], v[22:23]
    v_pk_mul_f32 v[16:17], v[48:49], s[42:43] op_sel_hi:[1,0]
    v_pk_mul_f32 v[18:19], v[50:51], s[42:43] op_sel_hi:[1,0]
    v_pk_mul_f32 v[20:21], v[52:53], s[42:43] op_sel_hi:[1,0]
    v_pk_mul_f32 v[22:23], v[54:55], s[42:43] op_sel_hi:[1,0]
    v_exp_f32 v16, v16 clamp
    v_exp_f32 v17, v17 clamp
    v_exp_f32 v18, v18 clamp
    v_exp_f32 v19, v19 clamp
    v_exp_f32 v20, v20 clamp
    v_exp_f32 v21, v21 clamp
    v_exp_f32 v22, v22 clamp
    v_exp_f32 v23, v23 clamp
    v_max_f32 v48, s40, v48
    v_max_f32 v49, s40, v49
    v_max_f32 v50, s40, v50
    v_max_f32 v51, s40, v51
    v_max_f32 v52, s40, v52
    v_max_f32 v53, s40, v53
    v_max_f32 v54, s40, v54
    v_max_f32 v55, s40, v55
    v_pk_add_f32 v[48:49], v[48:49], v[16:17]
    v_pk_add_f32 v[50:51], v[50:51], v[18:19]
    v_pk_add_f32 v[52:53], v[52:53], v[20:21]
    v_pk_add_f32 v[54:55], v[54:55], v[22:23]
    v_pk_mul_f32 v[56:57], v[56:57], v[104:105]
    v_pk_mul_f32 v[58:59], v[58:59], v[106:107]
    v_pk_mul_f32 v[60:61], v[60:61], v[108:109]
    v_pk_mul_f32 v[62:63], v[62:63], v[110:111]
    v_pk_mul_f32 v[64:65], v[64:65], v[112:113]
    v_pk_mul_f32 v[66:67], v[66:67], v[114:115]
    v_pk_mul_f32 v[68:69], v[68:69], v[116:117]
    v_pk_mul_f32 v[70:71], v[70:71], v[118:119]
    v_cvt_pk_bf16_f32 v16, v40, v41
    v_cvt_pk_bf16_f32 v17, v42, v43
    v_cvt_pk_bf16_f32 v18, v44, v45
    v_cvt_pk_bf16_f32 v19, v46, v47
    v_cvt_pk_bf16_f32 v20, v48, v49
    v_cvt_pk_bf16_f32 v21, v50, v51
    v_cvt_pk_bf16_f32 v22, v52, v53
    v_cvt_pk_bf16_f32 v23, v54, v55
    v_mov_b32 v32, 0
    v_mov_b32 v33, 0
    v_mov_b32 v34, s43
    v_cvt_pk_bf16_f32 v24, v56, v57
    v_cvt_pk_bf16_f32 v25, v58, v59
    v_cvt_pk_bf16_f32 v26, v60, v61
    v_cvt_pk_bf16_f32 v27, v62, v63
    v_cvt_pk_bf16_f32 v28, v64, v65
    v_cvt_pk_bf16_f32 v29, v66, v67
    v_cvt_pk_bf16_f32 v30, v68, v69
    v_cvt_pk_bf16_f32 v31, v70, v71
    v_dot2c_f32_bf16 v32, v16, v34
    v_dot2c_f32_bf16 v33, v17, v34
    v_dot2c_f32_bf16 v32, v18, v34
    v_dot2c_f32_bf16 v33, v19, v34
    v_dot2c_f32_bf16 v32, v20, v34
    v_dot2c_f32_bf16 v33, v21, v34
    v_dot2c_f32_bf16 v32, v22, v34
    v_dot2c_f32_bf16 v33, v23, v34
    v_mfma_f32_32x32x16_bf16 v[40:55], v[16:19], v[24:27], 0
    v_mfma_f32_32x32x16_bf16 v[40:55], v[20:23], v[28:31], v[40:55]
    s_nop 0
    v_add_f32 v32, v32, v33
    v_and_b32 v8, 16, v7
    v_cmp_eq_u32 vcc, 0, v8
    v_mov_b32 v33, v32
    s_mul_i32 s24, s18, 2304
    s_add_u32 s24, s24, 131072
    v_add_u32 v8, s24, v6
    v_permlane32_swap_b32 v32, v33
    v_and_b32 v9, 3, v7
    v_bfe_u32 v10, v7, 3, 1
    v_add_f32 v32, v32, v33
    v_lshl_add_u32 v9, v10, 2, v9
    v_bfe_u32 v10, v7, 4, 1
    v_bfe_u32 v11, v7, 2, 1
    v_lshl_add_u32 v10, v10, 1, v11
    v_lshl_add_u32 v9, v9, 2, v10
    v_lshlrev_b32 v9, 2, v9
    s_add_u32 s24, s24, 2048
    v_add_u32 v9, s24, v9
    s_mov_b32 exec_hi, 0
    ds_write_b32 v9, v32
    s_mov_b64 exec, -1
    v_cndmask_b32 v40, v48, v40, vcc
    v_cndmask_b32 v41, v49, v41, vcc
    v_cndmask_b32 v42, v50, v42, vcc
    v_cndmask_b32 v43, v51, v43, vcc
    v_cndmask_b32 v44, v52, v44, vcc
    v_cndmask_b32 v45, v53, v45, vcc
    v_cndmask_b32 v46, v54, v46, vcc
    v_cndmask_b32 v47, v55, v47, vcc
    ds_write2st64_b32 v8, v40, v41 offset0:0 offset1:1
    ds_write2st64_b32 v8, v42, v43 offset0:2 offset1:3
    ds_write2st64_b32 v8, v44, v45 offset0:4 offset1:5
    ds_write2st64_b32 v8, v46, v47 offset0:6 offset1:7
    s_waitcnt lgkmcnt(0)
    v_add_u32 v4, 98304, v2
    v_add_u32 v5, 114688, v2
    s_barrier
    ds_read_b64_tr_b16 v[16:17], v4 offset:0
    ds_read_b64_tr_b16 v[18:19], v4 offset:512
    ds_read_b64_tr_b16 v[20:21], v4 offset:1024
    ds_read_b64_tr_b16 v[22:23], v4 offset:1536
    ds_read_b64_tr_b16 v[24:25], v4 offset:2048
    ds_read_b64_tr_b16 v[26:27], v4 offset:2560
    ds_read_b64_tr_b16 v[28:29], v4 offset:3072
    ds_read_b64_tr_b16 v[30:31], v4 offset:3584
    ds_read_b64_tr_b16 v[32:33], v4 offset:4096
    ds_read_b64_tr_b16 v[34:35], v4 offset:4608
    s_waitcnt lgkmcnt(8)
    v_mfma_f32_32x32x16_bf16 v[72:87], v[16:19], v[128:131], 0
    v_and_b32 v10, 31, v7
    ds_read_b64_tr_b16 v[16:17], v4 offset:5120
    ds_read_b64_tr_b16 v[18:19], v4 offset:5632
    s_waitcnt lgkmcnt(8)
    v_mfma_f32_32x32x16_bf16 v[72:87], v[20:23], v[132:135], v[72:87]
    v_lshlrev_b32 v10, 4, v10
    ds_read_b64_tr_b16 v[20:21], v4 offset:6144
    ds_read_b64_tr_b16 v[22:23], v4 offset:6656
    s_waitcnt lgkmcnt(8)
    v_mfma_f32_32x32x16_bf16 v[72:87], v[24:27], v[136:139], v[72:87]
    v_add_u32 v10, 148480, v10
    ds_read_b64_tr_b16 v[24:25], v4 offset:7168
    ds_read_b64_tr_b16 v[26:27], v4 offset:7680
    s_waitcnt lgkmcnt(8)
    v_mfma_f32_32x32x16_bf16 v[72:87], v[28:31], v[140:143], v[72:87]
    ds_read_b128 v[88:91], v10
    ds_read_b64_tr_b16 v[28:29], v4 offset:8192
    ds_read_b64_tr_b16 v[30:31], v4 offset:8704
    s_waitcnt lgkmcnt(9)
    v_mfma_f32_32x32x16_bf16 v[72:87], v[32:35], v[144:147], v[72:87]
    s_waitcnt lgkmcnt(2)
    ds_read_b64_tr_b16 v[32:33], v4 offset:9216
    ds_read_b64_tr_b16 v[34:35], v4 offset:9728
    v_mfma_f32_32x32x16_bf16 v[72:87], v[16:19], v[148:151], v[72:87]
    v_add_f32 v88, v88, v89
    ds_read_b64_tr_b16 v[16:17], v4 offset:10240
    ds_read_b64_tr_b16 v[18:19], v4 offset:10752
    v_mfma_f32_32x32x16_bf16 v[72:87], v[20:23], v[152:155], v[72:87]
    v_add_f32 v90, v90, v91
    ds_read_b64_tr_b16 v[20:21], v4 offset:11264
    ds_read_b64_tr_b16 v[22:23], v4 offset:11776
    v_mfma_f32_32x32x16_bf16 v[72:87], v[24:27], v[156:159], v[72:87]
    v_add_f32 v91, v88, v90
    ds_read_b64_tr_b16 v[24:25], v4 offset:12288
    ds_read_b64_tr_b16 v[26:27], v4 offset:12800
    s_waitcnt lgkmcnt(8)
    v_mfma_f32_32x32x16_bf16 v[72:87], v[28:31], v[160:163], v[72:87]
    v_and_b32 v10, s41, v91
    ds_read_b64_tr_b16 v[28:29], v4 offset:13312
    ds_read_b64_tr_b16 v[30:31], v4 offset:13824
    s_waitcnt lgkmcnt(8)
    v_mfma_f32_32x32x16_bf16 v[72:87], v[32:35], v[164:167], v[72:87]
    v_sub_f32 v91, v91, v10
    ds_read_b64_tr_b16 v[32:33], v4 offset:14336
    ds_read_b64_tr_b16 v[34:35], v4 offset:14848
    s_waitcnt lgkmcnt(8)
    v_mfma_f32_32x32x16_bf16 v[72:87], v[16:19], v[168:171], v[72:87]
    v_lshrrev_b32 v88, 16, v10
    ds_read_b64_tr_b16 v[16:17], v4 offset:15360
    ds_read_b64_tr_b16 v[18:19], v4 offset:15872
    s_waitcnt lgkmcnt(8)
    v_mfma_f32_32x32x16_bf16 v[72:87], v[20:23], v[172:175], v[72:87]
    v_and_b32 v90, s41, v91
    ds_read_b64_tr_b16 v[20:21], v5 offset:0
    ds_read_b64_tr_b16 v[22:23], v5 offset:512
    s_waitcnt lgkmcnt(8)
    v_mfma_f32_32x32x16_bf16 v[72:87], v[24:27], v[176:179], v[72:87]
    v_or_b32 v88, v88, v10
    ds_read_b64_tr_b16 v[24:25], v5 offset:1024
    ds_read_b64_tr_b16 v[26:27], v5 offset:1536
    s_waitcnt lgkmcnt(8)
    v_mfma_f32_32x32x16_bf16 v[72:87], v[28:31], v[180:183], v[72:87]
    v_lshrrev_b32 v89, 16, v90
    ds_read_b64_tr_b16 v[28:29], v5 offset:2048
    ds_read_b64_tr_b16 v[30:31], v5 offset:2560
    s_waitcnt lgkmcnt(8)
    v_mfma_f32_32x32x16_bf16 v[72:87], v[32:35], v[184:187], v[72:87]
    v_or_b32 v89, v89, v90
    ds_read_b64_tr_b16 v[32:33], v5 offset:3072
    ds_read_b64_tr_b16 v[34:35], v5 offset:3584
    s_waitcnt lgkmcnt(8)
    v_mfma_f32_32x32x16_bf16 v[72:87], v[16:19], v[188:191], v[72:87]
    ds_read_b64_tr_b16 v[16:17], v5 offset:4096
    ds_read_b64_tr_b16 v[18:19], v5 offset:4608
    s_waitcnt lgkmcnt(8)
    v_mfma_f32_32x32x16_bf16 v[72:87], v[20:23], v[192:195], v[72:87]
    ds_read_b64_tr_b16 v[20:21], v5 offset:5120
    ds_read_b64_tr_b16 v[22:23], v5 offset:5632
    s_waitcnt lgkmcnt(8)
    v_mfma_f32_32x32x16_bf16 v[72:87], v[24:27], v[196:199], v[72:87]
    ds_read_b64_tr_b16 v[24:25], v5 offset:6144
    ds_read_b64_tr_b16 v[26:27], v5 offset:6656
    s_waitcnt lgkmcnt(8)
    v_mfma_f32_32x32x16_bf16 v[72:87], v[28:31], v[200:203], v[72:87]
    ds_read_b64_tr_b16 v[28:29], v5 offset:7168
    ds_read_b64_tr_b16 v[30:31], v5 offset:7680
    s_waitcnt lgkmcnt(8)
    v_mfma_f32_32x32x16_bf16 v[72:87], v[32:35], v[204:207], v[72:87]
    ds_read_b64_tr_b16 v[32:33], v5 offset:8192
    ds_read_b64_tr_b16 v[34:35], v5 offset:8704
    s_waitcnt lgkmcnt(8)
    v_mfma_f32_32x32x16_bf16 v[72:87], v[16:19], v[208:211], v[72:87]
    ds_read_b64_tr_b16 v[16:17], v5 offset:9216
    ds_read_b64_tr_b16 v[18:19], v5 offset:9728
    s_waitcnt lgkmcnt(8)
    v_mfma_f32_32x32x16_bf16 v[72:87], v[20:23], v[212:215], v[72:87]
    ds_read_b64_tr_b16 v[20:21], v5 offset:10240
    ds_read_b64_tr_b16 v[22:23], v5 offset:10752
    s_waitcnt lgkmcnt(8)
    v_mfma_f32_32x32x16_bf16 v[72:87], v[24:27], v[216:219], v[72:87]
    ds_read_b64_tr_b16 v[24:25], v5 offset:11264
    ds_read_b64_tr_b16 v[26:27], v5 offset:11776
    s_waitcnt lgkmcnt(8)
    v_mfma_f32_32x32x16_bf16 v[72:87], v[28:31], v[220:223], v[72:87]
    ds_read_b64_tr_b16 v[28:29], v5 offset:12288
    ds_read_b64_tr_b16 v[30:31], v5 offset:12800
    s_waitcnt lgkmcnt(8)
    v_mfma_f32_32x32x16_bf16 v[72:87], v[32:35], v[224:227], v[72:87]
    ds_read_b64_tr_b16 v[32:33], v5 offset:13312
    ds_read_b64_tr_b16 v[34:35], v5 offset:13824
    s_waitcnt lgkmcnt(8)
    v_mfma_f32_32x32x16_bf16 v[72:87], v[16:19], v[228:231], v[72:87]
    ds_read_b64_tr_b16 v[16:17], v5 offset:14336
    ds_read_b64_tr_b16 v[18:19], v5 offset:14848
    s_waitcnt lgkmcnt(8)
    v_mfma_f32_32x32x16_bf16 v[72:87], v[20:23], v[232:235], v[72:87]
    ds_read_b64_tr_b16 v[20:21], v5 offset:15360
    ds_read_b64_tr_b16 v[22:23], v5 offset:15872
    s_waitcnt lgkmcnt(8)
    v_mfma_f32_32x32x16_bf16 v[72:87], v[24:27], v[236:239], v[72:87]
    s_waitcnt lgkmcnt(6)
    v_mfma_f32_32x32x16_bf16 v[72:87], v[28:31], v[240:243], v[72:87]
    s_waitcnt lgkmcnt(4)
    v_mfma_f32_32x32x16_bf16 v[72:87], v[32:35], v[244:247], v[72:87]
    s_waitcnt lgkmcnt(2)
    v_mfma_f32_32x32x16_bf16 v[72:87], v[16:19], v[248:251], v[72:87]
    s_waitcnt lgkmcnt(0)
    v_mfma_f32_32x32x16_bf16 v[72:87], v[20:23], v[252:255], v[72:87]
    v_mfma_f32_32x32x16_bf16 v[72:87], v[88:91], v[124:127], v[72:87]
    s_nop 11
    v_pk_fma_f32 v[72:73], v[72:73], v[120:121], s[40:41] op_sel_hi:[1,0,0]
    v_pk_fma_f32 v[74:75], v[74:75], v[120:121], s[40:41] op_sel_hi:[1,0,0]
    v_pk_fma_f32 v[76:77], v[76:77], v[120:121], s[40:41] op_sel_hi:[1,0,0]
    v_pk_fma_f32 v[78:79], v[78:79], v[120:121], s[40:41] op_sel_hi:[1,0,0]
    v_pk_fma_f32 v[80:81], v[80:81], v[120:121], s[40:41] op_sel_hi:[1,0,0]
    v_pk_fma_f32 v[82:83], v[82:83], v[120:121], s[40:41] op_sel_hi:[1,0,0]
    v_pk_fma_f32 v[84:85], v[84:85], v[120:121], s[40:41] op_sel_hi:[1,0,0]
    v_pk_fma_f32 v[86:87], v[86:87], v[120:121], s[40:41] op_sel_hi:[1,0,0]
    v_pk_mul_f32 v[16:17], v[72:73], s[42:43] op_sel_hi:[1,0]
    v_pk_mul_f32 v[18:19], v[74:75], s[42:43] op_sel_hi:[1,0]
    v_pk_mul_f32 v[20:21], v[76:77], s[42:43] op_sel_hi:[1,0]
    v_pk_mul_f32 v[22:23], v[78:79], s[42:43] op_sel_hi:[1,0]
    v_exp_f32 v16, v16 clamp
    v_exp_f32 v17, v17 clamp
    v_exp_f32 v18, v18 clamp
    v_exp_f32 v19, v19 clamp
    v_exp_f32 v20, v20 clamp
    v_exp_f32 v21, v21 clamp
    v_exp_f32 v22, v22 clamp
    v_exp_f32 v23, v23 clamp
    v_max_f32 v72, s40, v72
    v_max_f32 v73, s40, v73
    v_max_f32 v74, s40, v74
    v_max_f32 v75, s40, v75
    v_max_f32 v76, s40, v76
    v_max_f32 v77, s40, v77
    v_max_f32 v78, s40, v78
    v_max_f32 v79, s40, v79
    v_pk_add_f32 v[72:73], v[72:73], v[16:17]
    v_pk_add_f32 v[74:75], v[74:75], v[18:19]
    v_pk_add_f32 v[76:77], v[76:77], v[20:21]
    v_pk_add_f32 v[78:79], v[78:79], v[22:23]
    v_pk_mul_f32 v[16:17], v[80:81], s[42:43] op_sel_hi:[1,0]
    v_pk_mul_f32 v[18:19], v[82:83], s[42:43] op_sel_hi:[1,0]
    v_pk_mul_f32 v[20:21], v[84:85], s[42:43] op_sel_hi:[1,0]
    v_pk_mul_f32 v[22:23], v[86:87], s[42:43] op_sel_hi:[1,0]
    v_exp_f32 v16, v16 clamp
    v_exp_f32 v17, v17 clamp
    v_exp_f32 v18, v18 clamp
    v_exp_f32 v19, v19 clamp
    v_exp_f32 v20, v20 clamp
    v_exp_f32 v21, v21 clamp
    v_exp_f32 v22, v22 clamp
    v_exp_f32 v23, v23 clamp
    v_max_f32 v80, s40, v80
    v_max_f32 v81, s40, v81
    v_max_f32 v82, s40, v82
    v_max_f32 v83, s40, v83
    v_max_f32 v84, s40, v84
    v_max_f32 v85, s40, v85
    v_max_f32 v86, s40, v86
    v_max_f32 v87, s40, v87
    v_pk_add_f32 v[80:81], v[80:81], v[16:17]
    v_pk_add_f32 v[82:83], v[82:83], v[18:19]
    v_pk_add_f32 v[84:85], v[84:85], v[20:21]
    v_pk_add_f32 v[86:87], v[86:87], v[22:23]
    v_cvt_pk_bf16_f32 v104, v72, v73
    v_cvt_pk_bf16_f32 v105, v74, v75
    v_cvt_pk_bf16_f32 v106, v76, v77
    v_cvt_pk_bf16_f32 v107, v78, v79
    v_cvt_pk_bf16_f32 v108, v80, v81
    v_cvt_pk_bf16_f32 v109, v82, v83
    v_cvt_pk_bf16_f32 v110, v84, v85
    v_cvt_pk_bf16_f32 v111, v86, v87
    v_add_u32 v8, 153088, v1
    s_lshl_b32 s24, s18, 15
    s_lshl_b32 s25, s17, 11
    s_add_u32 s24, s24, s25
    s_add_u32 s24, s24, s21
    s_add_u32 s29, s24, 147456
    s_barrier
    ds_read_b128 v[16:19], v8 offset:0
    ds_read_b128 v[20:23], v8 offset:1024
    ds_read_b128 v[24:27], v8 offset:2048
    ds_read_b128 v[28:31], v8 offset:3072
    s_waitcnt lgkmcnt(1)
    v_mfma_f32_32x32x16_bf16 v[56:71], v[24:27], v[104:107], 0
    v_mfma_f32_32x32x16_bf16 v[40:55], v[16:19], v[104:107], 0
    s_waitcnt lgkmcnt(0)
    v_mfma_f32_32x32x16_bf16 v[56:71], v[28:31], v[108:111], v[56:71]
    v_mfma_f32_32x32x16_bf16 v[40:55], v[20:23], v[108:111], v[40:55]
    s_add_u32 s27, s55, s21
    buffer_load_dwordx4 v[72:75], v1, s[4:7], s27 offen sc1
    buffer_load_dwordx4 v[76:79], v1, s[4:7], s27 offen offset:1024 sc1
    s_nop 7
    v_add_f32 v8, s40, v56
    v_add_f32 v10, s40, v64
    v_rcp_f32 v8, v8
    v_rcp_f32 v10, v10
    v_pk_mul_f32 v[40:41], v[40:41], v[8:9] op_sel_hi:[1,0]
    v_pk_mul_f32 v[42:43], v[42:43], v[8:9] op_sel_hi:[1,0]
    v_pk_mul_f32 v[44:45], v[44:45], v[8:9] op_sel_hi:[1,0]
    v_pk_mul_f32 v[46:47], v[46:47], v[8:9] op_sel_hi:[1,0]
    v_pk_mul_f32 v[48:49], v[48:49], v[10:11] op_sel_hi:[1,0]
    v_pk_mul_f32 v[50:51], v[50:51], v[10:11] op_sel_hi:[1,0]
    v_pk_mul_f32 v[52:53], v[52:53], v[10:11] op_sel_hi:[1,0]
    v_pk_mul_f32 v[54:55], v[54:55], v[10:11] op_sel_hi:[1,0]
    v_cvt_pk_bf16_f32 v104, v40, v41
    v_cvt_pk_bf16_f32 v105, v42, v43
    v_cvt_pk_bf16_f32 v106, v44, v45
    v_cvt_pk_bf16_f32 v107, v46, v47
    v_cvt_pk_bf16_f32 v108, v48, v49
    v_cvt_pk_bf16_f32 v109, v50, v51
    v_cvt_pk_bf16_f32 v110, v52, v53
    v_cvt_pk_bf16_f32 v111, v54, v55
    buffer_store_dwordx4 v[104:107], v1, s[4:7], s29 offen
    buffer_store_dwordx4 v[108:111], v1, s[4:7], s29 offen offset:1024
    s_add_u32 s20, s20, 16
    v_mov_b32 v11, 0
    v_mov_b32 v12, s20
    s_waitcnt vmcnt(0)
    s_cmp_lg_u32 s19, 0
    s_cbranch_scc1 Lsg13
    s_mov_b64 exec, 1
    buffer_store_dword v12, v11, s[4:7], s51 offen
    s_mov_b64 exec, -1
Lsb14:
    s_mov_b32 s48, 0
Lp17:
    buffer_load_dword v13, v6, s[4:7], s44 offen sc1
    s_waitcnt vmcnt(0)
    v_subrev_u32 v13, s20, v13
    v_cmp_gt_u32 vcc, 0x400, v13
    s_nop 1
    s_cmp_eq_u64 vcc, -1
    s_cbranch_scc1 Lpd18
    s_add_u32 s48, s48, 1
    s_cmp_lt_u32 s48, 400000
    s_cbranch_scc1 Lp17
    s_mov_b32 s49, 1
Lpd18:
    s_cmp_lg_u32 s19, 0
    s_cbranch_scc1 Lwi15
Lwb16:
    s_lshl_b32 s54, s45, 15
    s_lshl_b32 s28, s47, 14
    s_add_u32 s54, s54, s28
    s_add_u32 s54, s54, s21
    s_add_u32 s54, s54, 147456
    s_mov_b32 s26, s54
    buffer_load_dwordx4 v[192:195], v1, s[4:7], s26 offen offset:0 sc1
    buffer_load_dwordx4 v[196:199], v1, s[4:7], s26 offen offset:1024 sc1
    v_add_u32 v4, 0, v3
    v_add_u32 v5, 16384, v3
    ds_read_b64_tr_b16 v[16:17], v4 offset:0
    ds_read_b64_tr_b16 v[18:19], v4 offset:512
    ds_read_b64_tr_b16 v[20:21], v4 offset:1024
    ds_read_b64_tr_b16 v[22:23], v4 offset:1536
    ds_read_b64_tr_b16 v[24:25], v4 offset:4096
    ds_read_b64_tr_b16 v[26:27], v4 offset:4608
    ds_read_b64_tr_b16 v[28:29], v4 offset:5120
    ds_read_b64_tr_b16 v[30:31], v4 offset:5632
    buffer_load_dwordx4 v[200:203], v1, s[4:7], s26 offen offset:2048 sc1
    buffer_load_dwordx4 v[204:207], v1, s[4:7], s26 offen offset:3072 sc1
    s_add_u32 s26, s54, 4096
    buffer_load_dwordx4 v[208:211], v1, s[4:7], s26 offen offset:0 sc1
    buffer_load_dwordx4 v[212:215], v1, s[4:7], s26 offen offset:1024 sc1
    buffer_load_dwordx4 v[216:219], v1, s[4:7], s26 offen offset:2048 sc1
    buffer_load_dwordx4 v[220:223], v1, s[4:7], s26 offen offset:3072 sc1
    s_add_u32 s26, s54, 8192
    buffer_load_dwordx4 v[224:227], v1, s[4:7], s26 offen offset:0 sc1
    buffer_load_dwordx4 v[228:231], v1, s[4:7], s26 offen offset:1024 sc1
    buffer_load_dwordx4 v[232:235], v1, s[4:7], s26 offen offset:2048 sc1
    ds_read_b64_tr_b16 v[32:33], v4 offset:8192
    ds_read_b64_tr_b16 v[34:35], v4 offset:8704
    s_waitcnt vmcnt(10) lgkmcnt(6)
    v_mfma_f32_32x32x16_bf16 v[40:55], v[16:19], v[192:195], 0
    ds_read_b64_tr_b16 v[36:37], v4 offset:9216
    ds_read_b64_tr_b16 v[38:39], v4 offset:9728
    v_mfma_f32_32x32x16_bf16 v[56:71], v[20:23], v[192:195], 0
    buffer_load_dwordx4 v[236:239], v1, s[4:7], s26 offen offset:3072 sc1
    ds_read_b64_tr_b16 v[16:17], v4 offset:12288
    ds_read_b64_tr_b16 v[18:19], v4 offset:12800
    s_waitcnt vmcnt(10) lgkmcnt(6)
    v_mfma_f32_32x32x16_bf16 v[40:55], v[24:27], v[196:199], v[40:55]
    ds_read_b64_tr_b16 v[20:21], v4 offset:13312
    ds_read_b64_tr_b16 v[22:23], v4 offset:13824
    v_mfma_f32_32x32x16_bf16 v[56:71], v[28:31], v[196:199], v[56:71]
    s_add_u32 s26, s54, 12288
    buffer_load_dwordx4 v[240:243], v1, s[4:7], s26 offen offset:0 sc1
    ds_read_b64_tr_b16 v[24:25], v5 offset:0
    ds_read_b64_tr_b16 v[26:27], v5 offset:512
    s_waitcnt vmcnt(10) lgkmcnt(6)
    v_mfma_f32_32x32x16_bf16 v[40:55], v[32:35], v[200:203], v[40:55]
    ds_read_b64_tr_b16 v[28:29], v5 offset:1024
    ds_read_b64_tr_b16 v[30:31], v5 offset:1536
    v_mfma_f32_32x32x16_bf16 v[56:71], v[36:39], v[200:203], v[56:71]
    buffer_load_dwordx4 v[244:247], v1, s[4:7], s26 offen offset:1024 sc1
    ds_read_b64_tr_b16 v[32:33], v5 offset:4096
    ds_read_b64_tr_b16 v[34:35], v5 offset:4608
    s_waitcnt vmcnt(10) lgkmcnt(6)
    v_mfma_f32_32x32x16_bf16 v[40:55], v[16:19], v[204:207], v[40:55]
    ds_read_b64_tr_b16 v[36:37], v5 offset:5120
    ds_read_b64_tr_b16 v[38:39], v5 offset:5632
    v_mfma_f32_32x32x16_bf16 v[56:71], v[20:23], v[204:207], v[56:71]
    v_add_u32 v4, 32768, v3
    buffer_load_dwordx4 v[248:251], v1, s[4:7], s26 offen offset:2048 sc1
    ds_read_b64_tr_b16 v[16:17], v5 offset:8192
    ds_read_b64_tr_b16 v[18:19], v5 offset:8704
    s_waitcnt vmcnt(10) lgkmcnt(6)
    v_mfma_f32_32x32x16_bf16 v[40:55], v[24:27], v[208:211], v[40:55]
    ds_read_b64_tr_b16 v[20:21], v5 offset:9216
    ds_read_b64_tr_b16 v[22:23], v5 offset:9728
    v_mfma_f32_32x32x16_bf16 v[56:71], v[28:31], v[208:211], v[56:71]
    buffer_load_dwordx4 v[252:255], v1, s[4:7], s26 offen offset:3072 sc1
    ds_read_b64_tr_b16 v[24:25], v5 offset:12288
    ds_read_b64_tr_b16 v[26:27], v5 offset:12800
    s_waitcnt vmcnt(10) lgkmcnt(6)
    v_mfma_f32_32x32x16_bf16 v[40:55], v[32:35], v[212:215], v[40:55]
    ds_read_b64_tr_b16 v[28:29], v5 offset:13312
    ds_read_b64_tr_b16 v[30:31], v5 offset:13824
    v_mfma_f32_32x32x16_bf16 v[56:71], v[36:39], v[212:215], v[56:71]
    ds_read_b64_tr_b16 v[32:33], v4 offset:0
    ds_read_b64_tr_b16 v[34:35], v4 offset:512
    s_waitcnt vmcnt(9) lgkmcnt(6)
    v_mfma_f32_32x32x16_bf16 v[40:55], v[16:19], v[216:219], v[40:55]
    ds_read_b64_tr_b16 v[36:37], v4 offset:1024
    ds_read_b64_tr_b16 v[38:39], v4 offset:1536
    v_mfma_f32_32x32x16_bf16 v[56:71], v[20:23], v[216:219], v[56:71]
    ds_read_b64_tr_b16 v[16:17], v4 offset:4096
    ds_read_b64_tr_b16 v[18:19], v4 offset:4608
    s_waitcnt vmcnt(8) lgkmcnt(6)
    v_mfma_f32_32x32x16_bf16 v[40:55], v[24:27], v[220:223], v[40:55]
    ds_read_b64_tr_b16 v[20:21], v4 offset:5120
    ds_read_b64_tr_b16 v[22:23], v4 offset:5632
    v_mfma_f32_32x32x16_bf16 v[56:71], v[28:31], v[220:223], v[56:71]
    v_add_u32 v5, 49152, v3
    ds_read_b64_tr_b16 v[24:25], v4 offset:8192
    ds_read_b64_tr_b16 v[26:27], v4 offset:8704
    s_waitcnt vmcnt(7) lgkmcnt(6)
    v_mfma_f32_32x32x16_bf16 v[40:55], v[32:35], v[224:227], v[40:55]
    ds_read_b64_tr_b16 v[28:29], v4 offset:9216
    ds_read_b64_tr_b16 v[30:31], v4 offset:9728
    v_mfma_f32_32x32x16_bf16 v[56:71], v[36:39], v[224:227], v[56:71]
    ds_read_b64_tr_b16 v[32:33], v4 offset:12288
    ds_read_b64_tr_b16 v[34:35], v4 offset:12800
    s_waitcnt vmcnt(6) lgkmcnt(6)
    v_mfma_f32_32x32x16_bf16 v[40:55], v[16:19], v[228:231], v[40:55]
    ds_read_b64_tr_b16 v[36:37], v4 offset:13312
    ds_read_b64_tr_b16 v[38:39], v4 offset:13824
    v_mfma_f32_32x32x16_bf16 v[56:71], v[20:23], v[228:231], v[56:71]
    ds_read_b64_tr_b16 v[16:17], v5 offset:0
    ds_read_b64_tr_b16 v[18:19], v5 offset:512
    s_waitcnt vmcnt(5) lgkmcnt(6)
    v_mfma_f32_32x32x16_bf16 v[40:55], v[24:27], v[232:235], v[40:55]
    ds_read_b64_tr_b16 v[20:21], v5 offset:1024
    ds_read_b64_tr_b16 v[22:23], v5 offset:1536
    v_mfma_f32_32x32x16_bf16 v[56:71], v[28:31], v[232:235], v[56:71]
    ds_read_b64_tr_b16 v[24:25], v5 offset:4096
    ds_read_b64_tr_b16 v[26:27], v5 offset:4608
    s_waitcnt vmcnt(4) lgkmcnt(6)
    v_mfma_f32_32x32x16_bf16 v[40:55], v[32:35], v[236:239], v[40:55]
    ds_read_b64_tr_b16 v[28:29], v5 offset:5120
    ds_read_b64_tr_b16 v[30:31], v5 offset:5632
    v_mfma_f32_32x32x16_bf16 v[56:71], v[36:39], v[236:239], v[56:71]
    ds_read_b64_tr_b16 v[32:33], v5 offset:8192
    ds_read_b64_tr_b16 v[34:35], v5 offset:8704
    s_waitcnt vmcnt(3) lgkmcnt(6)
    v_mfma_f32_32x32x16_bf16 v[40:55], v[16:19], v[240:243], v[40:55]
    ds_read_b64_tr_b16 v[36:37], v5 offset:9216
    ds_read_b64_tr_b16 v[38:39], v5 offset:9728
    v_mfma_f32_32x32x16_bf16 v[56:71], v[20:23], v[240:243], v[56:71]
    ds_read_b64_tr_b16 v[16:17], v5 offset:12288
    ds_read_b64_tr_b16 v[18:19], v5 offset:12800
    s_waitcnt vmcnt(2) lgkmcnt(6)
    v_mfma_f32_32x32x16_bf16 v[40:55], v[24:27], v[244:247], v[40:55]
    ds_read_b64_tr_b16 v[20:21], v5 offset:13312
    ds_read_b64_tr_b16 v[22:23], v5 offset:13824
    v_mfma_f32_32x32x16_bf16 v[56:71], v[28:31], v[244:247], v[56:71]
    s_waitcnt vmcnt(1) lgkmcnt(4)
    v_mfma_f32_32x32x16_bf16 v[40:55], v[32:35], v[248:251], v[40:55]
    v_mfma_f32_32x32x16_bf16 v[56:71], v[36:39], v[248:251], v[56:71]
    s_waitcnt vmcnt(0) lgkmcnt(0)
    v_mfma_f32_32x32x16_bf16 v[40:55], v[16:19], v[252:255], v[40:55]
    v_mfma_f32_32x32x16_bf16 v[56:71], v[20:23], v[252:255], v[56:71]
    s_lshl_b32 s24, s18, 12
    s_add_u32 s24, s24, 131072
    v_add_u32 v8, s24, v1
    s_xor_b32 s25, s18, 2
    s_lshl_b32 s25, s25, 12
    s_add_u32 s25, s25, 131072
    v_add_u32 v9, s25, v1
    s_nop 4
    ds_write_b128 v8, v[56:59] offset:0
    ds_write_b128 v8, v[60:63] offset:1024
    ds_write_b128 v8, v[64:67] offset:2048
    ds_write_b128 v8, v[68:71] offset:3072
    v_lshlrev_b32 v104, 16, v72
    v_and_b32 v105, s41, v72
    v_lshlrev_b32 v106, 16, v73
    v_and_b32 v107, s41, v73
    v_lshlrev_b32 v108, 16, v74
    v_and_b32 v109, s41, v74
    v_lshlrev_b32 v110, 16, v75
    v_and_b32 v111, s41, v75
    v_lshlrev_b32 v112, 16, v76
    v_and_b32 v113, s41, v76
    v_lshlrev_b32 v114, 16, v77
    v_and_b32 v115, s41, v77
    v_lshlrev_b32 v116, 16, v78
    v_and_b32 v117, s41, v78
    v_lshlrev_b32 v118, 16, v79
    v_and_b32 v119, s41, v79
    v_pk_add_f32 v[40:41], v[40:41], v[104:105]
    v_pk_add_f32 v[42:43], v[42:43], v[106:107]
    v_pk_add_f32 v[44:45], v[44:45], v[108:109]
    v_pk_add_f32 v[46:47], v[46:47], v[110:111]
    v_pk_add_f32 v[48:49], v[48:49], v[112:113]
    v_pk_add_f32 v[50:51], v[50:51], v[114:115]
    v_pk_add_f32 v[52:53], v[52:53], v[116:117]
    v_pk_add_f32 v[54:55], v[54:55], v[118:119]
    s_waitcnt lgkmcnt(0)
    s_barrier
    ds_read_b128 v[56:59], v9 offset:0
    ds_read_b128 v[60:63], v9 offset:1024
    ds_read_b128 v[64:67], v9 offset:2048
    ds_read_b128 v[68:71], v9 offset:3072
    s_add_u32 s24, s55, s21
    s_waitcnt lgkmcnt(3)
    v_pk_add_f32 v[40:41], v[40:41], v[56:57]
    v_pk_add_f32 v[42:43], v[42:43], v[58:59]
    s_waitcnt lgkmcnt(2)
    v_pk_add_f32 v[44:45], v[44:45], v[60:61]
    v_pk_add_f32 v[46:47], v[46:47], v[62:63]
    s_waitcnt lgkmcnt(1)
    v_pk_add_f32 v[48:49], v[48:49], v[64:65]
    v_pk_add_f32 v[50:51], v[50:51], v[66:67]
    s_waitcnt lgkmcnt(0)
    v_pk_add_f32 v[52:53], v[52:53], v[68:69]
    v_pk_add_f32 v[54:55], v[54:55], v[70:71]
    v_cvt_pk_bf16_f32 v72, v40, v41
    v_cvt_pk_bf16_f32 v73, v42, v43
    v_cvt_pk_bf16_f32 v74, v44, v45
    v_cvt_pk_bf16_f32 v75, v46, v47
    v_cvt_pk_bf16_f32 v76, v48, v49
    v_cvt_pk_bf16_f32 v77, v50, v51
    v_cvt_pk_bf16_f32 v78, v52, v53
    v_cvt_pk_bf16_f32 v79, v54, v55
    buffer_store_dwordx4 v[72:75], v1, s[4:7], s24 offen
    buffer_store_dwordx4 v[76:79], v1, s[4:7], s24 offen offset:1024
    v_mov_b32 v10, 0
    v_mov_b32 v11, 0
    v_mov_b32 v12, s43
    s_lshl_b32 s24, s45, 12
    s_lshl_b32 s25, s46, 9
    s_add_u32 s24, s24, s25
    s_lshl_b32 s25, s47, 8
    s_add_u32 s24, s24, s25
    s_add_u32 s24, s24, s21
    s_add_u32 s24, s24, 131072
    v_dot2c_f32_bf16 v10, v72, v12
    v_dot2c_f32_bf16 v11, v72, v72
    v_dot2c_f32_bf16 v10, v73, v12
    v_dot2c_f32_bf16 v11, v73, v73
    v_dot2c_f32_bf16 v10, v74, v12
    v_dot2c_f32_bf16 v11, v74, v74
    v_dot2c_f32_bf16 v10, v75, v12
    v_dot2c_f32_bf16 v11, v75, v75
    v_dot2c_f32_bf16 v10, v76, v12
    v_dot2c_f32_bf16 v11, v76, v76
    v_dot2c_f32_bf16 v10, v77, v12
    v_dot2c_f32_bf16 v11, v77, v77
    v_dot2c_f32_bf16 v10, v78, v12
    v_dot2c_f32_bf16 v11, v78, v78
    v_dot2c_f32_bf16 v10, v79, v12
    v_dot2c_f32_bf16 v11, v79, v79
    v_and_b32 v8, 31, v7
    v_lshlrev_b32 v8, 3, v8
    v_mov_b32 v104, v10
    v_mov_b32 v105, v11
    s_nop 0
    v_permlane32_swap_b32 v10, v104
    v_permlane32_swap_b32 v11, v105
    v_add_f32 v10, v10, v104
    v_add_f32 v11, v11, v105
    s_mov_b32 exec_hi, 0
    buffer_store_dwordx2 v[10:11], v8, s[4:7], s24 offen
    s_mov_b64 exec, -1
    s_add_u32 s20, s20, 16
    v_mov_b32 v11, 0
    v_mov_b32 v12, s20
    s_waitcnt vmcnt(0)
    s_cmp_lg_u32 s19, 0
    s_cbranch_scc1 Lsg21
    s_mov_b64 exec, 1
    buffer_store_dword v12, v11, s[4:7], s51 offen
    s_mov_b64 exec, -1
Lsb22:
    s_mov_b32 s48, 0
Lp25:
    buffer_load_dword v13, v6, s[4:7], s44 offen sc1
    s_waitcnt vmcnt(0)
    v_subrev_u32 v13, s20, v13
    v_cmp_gt_u32 vcc, 0x400, v13
    s_nop 1
    s_cmp_eq_u64 vcc, -1
    s_cbranch_scc1 Lpd26
    s_add_u32 s48, s48, 1
    s_cmp_lt_u32 s48, 400000
    s_cbranch_scc1 Lp25
    s_mov_b32 s49, 1
Lpd26:
    s_cmp_lg_u32 s19, 0
    s_cbranch_scc1 Lwi23
Lwb24:
    s_lshl_b32 s54, s18, 15
    s_add_u32 s54, s54, s21
    s_add_u32 s54, s54, 0
    s_mov_b32 s26, s54
    buffer_load_dwordx4 v[128:131], v1, s[4:7], s26 offen offset:0 sc1
    buffer_load_dwordx4 v[132:135], v1, s[4:7], s26 offen offset:1024 sc1
    s_mul_i32 s56, s18, 88064
    s_add_u32 s56, s56, s21
    s_add_u32 s56, s56, 147456
    v_add_u32 v4, 98304, v1
    v_add_u32 v5, 114688, v1
    s_barrier
    ds_read_b128 v[16:19], v4 offset:0
    ds_read_b128 v[20:23], v4 offset:1024
    ds_read_b128 v[24:27], v4 offset:2048
    ds_read_b128 v[28:31], v4 offset:3072
    buffer_load_dwordx4 v[136:139], v1, s[4:7], s26 offen offset:2048 sc1
    buffer_load_dwordx4 v[140:143], v1, s[4:7], s26 offen offset:3072 sc1
    s_add_u32 s26, s54, 4096
    buffer_load_dwordx4 v[144:147], v1, s[4:7], s26 offen offset:0 sc1
    buffer_load_dwordx4 v[148:151], v1, s[4:7], s26 offen offset:1024 sc1
    buffer_load_dwordx4 v[152:155], v1, s[4:7], s26 offen offset:2048 sc1
    buffer_load_dwordx4 v[156:159], v1, s[4:7], s26 offen offset:3072 sc1
    s_add_u32 s26, s54, 8192
    buffer_load_dwordx4 v[160:163], v1, s[4:7], s26 offen offset:0 sc1
    buffer_load_dwordx4 v[164:167], v1, s[4:7], s26 offen offset:1024 sc1
    buffer_load_dwordx4 v[168:171], v1, s[4:7], s26 offen offset:2048 sc1
    ds_read_b128 v[32:35], v4 offset:4096
    s_waitcnt vmcnt(10) lgkmcnt(3)
    v_mfma_f32_32x32x16_bf16 v[40:55], v[16:19], v[128:131], 0
    s_lshl_b32 s27, s18, 12
    s_add_u32 s27, s27, s21
    ds_read_b128 v[36:39], v4 offset:5120
    v_mfma_f32_32x32x16_bf16 v[56:71], v[20:23], v[128:131], 0
    s_add_u32 s27, s27, 131072
    buffer_load_dwordx4 v[172:175], v1, s[4:7], s26 offen offset:3072 sc1
    ds_read_b128 v[16:19], v4 offset:6144
    s_waitcnt vmcnt(10) lgkmcnt(3)
    v_mfma_f32_32x32x16_bf16 v[40:55], v[24:27], v[132:135], v[40:55]
    buffer_load_dwordx4 v[104:107], v1, s[4:7], s27 offen offset:0 sc1
    ds_read_b128 v[20:23], v4 offset:7168
    v_mfma_f32_32x32x16_bf16 v[56:71], v[28:31], v[132:135], v[56:71]
    buffer_load_dwordx4 v[108:111], v1, s[4:7], s27 offen offset:1024 sc1
    s_add_u32 s26, s54, 12288
    buffer_load_dwordx4 v[176:179], v1, s[4:7], s26 offen offset:0 sc1
    ds_read_b128 v[24:27], v4 offset:8192
    s_waitcnt vmcnt(12) lgkmcnt(3)
    v_mfma_f32_32x32x16_bf16 v[40:55], v[32:35], v[136:139], v[40:55]
    buffer_load_dwordx4 v[112:115], v1, s[4:7], s27 offen offset:2048 sc1
    ds_read_b128 v[28:31], v4 offset:9216
    v_mfma_f32_32x32x16_bf16 v[56:71], v[36:39], v[136:139], v[56:71]
    buffer_load_dwordx4 v[116:119], v1, s[4:7], s27 offen offset:3072 sc1
    buffer_load_dwordx4 v[180:183], v1, s[4:7], s26 offen offset:1024 sc1
    ds_read_b128 v[32:35], v4 offset:10240
    s_waitcnt vmcnt(14) lgkmcnt(3)
    v_mfma_f32_32x32x16_bf16 v[40:55], v[16:19], v[140:143], v[40:55]
    ds_read_b128 v[36:39], v4 offset:11264
    v_mfma_f32_32x32x16_bf16 v[56:71], v[20:23], v[140:143], v[56:71]
    buffer_load_dwordx4 v[184:187], v1, s[4:7], s26 offen offset:2048 sc1
    ds_read_b128 v[16:19], v4 offset:12288
    s_waitcnt vmcnt(14) lgkmcnt(3)
    v_mfma_f32_32x32x16_bf16 v[40:55], v[24:27], v[144:147], v[40:55]
    ds_read_b128 v[20:23], v4 offset:13312
    v_mfma_f32_32x32x16_bf16 v[56:71], v[28:31], v[144:147], v[56:71]
    buffer_load_dwordx4 v[188:191], v1, s[4:7], s26 offen offset:3072 sc1
    ds_read_b128 v[24:27], v4 offset:14336
    s_waitcnt vmcnt(14) lgkmcnt(3)
    v_mfma_f32_32x32x16_bf16 v[40:55], v[32:35], v[148:151], v[40:55]
    ds_read_b128 v[28:31], v4 offset:15360
    v_mfma_f32_32x32x16_bf16 v[56:71], v[36:39], v[148:151], v[56:71]
    s_add_u32 s26, s54, 16384
    buffer_load_dwordx4 v[192:195], v1, s[4:7], s26 offen offset:0 sc1
    ds_read_b128 v[32:35], v5 offset:0
    s_waitcnt vmcnt(14) lgkmcnt(3)
    v_mfma_f32_32x32x16_bf16 v[40:55], v[16:19], v[152:155], v[40:55]
    ds_read_b128 v[36:39], v5 offset:1024
    v_mfma_f32_32x32x16_bf16 v[56:71], v[20:23], v[152:155], v[56:71]
    buffer_load_dwordx4 v[196:199], v1, s[4:7], s26 offen offset:1024 sc1
    ds_read_b128 v[16:19], v5 offset:2048
    s_waitcnt vmcnt(14) lgkmcnt(3)
    v_mfma_f32_32x32x16_bf16 v[40:55], v[24:27], v[156:159], v[40:55]
    ds_read_b128 v[20:23], v5 offset:3072
    v_mfma_f32_32x32x16_bf16 v[56:71], v[28:31], v[156:159], v[56:71]
    s_barrier
    v_add_u32 v4, 131072, v1
    buffer_load_dwordx4 v[200:203], v1, s[4:7], s26 offen offset:2048 sc1
    ds_read_b128 v[24:27], v5 offset:4096
    s_waitcnt vmcnt(14) lgkmcnt(3)
    v_mfma_f32_32x32x16_bf16 v[40:55], v[32:35], v[160:163], v[40:55]
    ds_read_b128 v[28:31], v5 offset:5120
    v_mfma_f32_32x32x16_bf16 v[56:71], v[36:39], v[160:163], v[56:71]
    buffer_load_dwordx4 v[204:207], v1, s[4:7], s26 offen offset:3072 sc1
    ds_read_b128 v[32:35], v5 offset:6144
    s_waitcnt vmcnt(14) lgkmcnt(3)
    v_mfma_f32_32x32x16_bf16 v[40:55], v[16:19], v[164:167], v[40:55]
    s_waitcnt vmcnt(7)
    v_add_f32 v104, v104, v108
    ds_read_b128 v[36:39], v5 offset:7168
    v_mfma_f32_32x32x16_bf16 v[56:71], v[20:23], v[164:167], v[56:71]
    v_add_f32 v105, v105, v109
    v_add_f32 v106, v106, v110
    s_add_u32 s26, s54, 20480
    buffer_load_dwordx4 v[208:211], v1, s[4:7], s26 offen offset:0 sc1
    ds_read_b128 v[16:19], v5 offset:8192
    s_waitcnt lgkmcnt(3)
    v_mfma_f32_32x32x16_bf16 v[40:55], v[24:27], v[168:171], v[40:55]
    v_add_f32 v107, v107, v111
    v_add_f32 v112, v112, v116
    ds_read_b128 v[20:23], v5 offset:9216
    v_mfma_f32_32x32x16_bf16 v[56:71], v[28:31], v[168:171], v[56:71]
    v_add_f32 v113, v113, v117
    v_add_f32 v114, v114, v118
    buffer_load_dwordx4 v[212:215], v1, s[4:7], s26 offen offset:1024 sc1
    ds_read_b128 v[24:27], v5 offset:10240
    s_waitcnt lgkmcnt(3)
    v_mfma_f32_32x32x16_bf16 v[40:55], v[32:35], v[172:175], v[40:55]
    v_add_f32 v115, v115, v119
    v_add_f32 v104, v104, v112
    ds_read_b128 v[28:31], v5 offset:11264
    v_mfma_f32_32x32x16_bf16 v[56:71], v[36:39], v[172:175], v[56:71]
    v_add_f32 v105, v105, v113
    v_add_f32 v106, v106, v114
    buffer_load_dwordx4 v[216:219], v1, s[4:7], s26 offen offset:2048 sc1
    ds_read_b128 v[32:35], v5 offset:12288
    s_waitcnt lgkmcnt(3)
    v_mfma_f32_32x32x16_bf16 v[40:55], v[16:19], v[176:179], v[40:55]
    v_add_f32 v107, v107, v115
    v_and_b32 v112, 31, v7
    ds_read_b128 v[36:39], v5 offset:13312
    v_mfma_f32_32x32x16_bf16 v[56:71], v[20:23], v[176:179], v[56:71]
    v_and_b32 v113, 1, v7
    v_permlane16_swap_b32 v104, v106
    buffer_load_dwordx4 v[220:223], v1, s[4:7], s26 offen offset:3072 sc1
    ds_read_b128 v[16:19], v5 offset:14336
    s_waitcnt vmcnt(10) lgkmcnt(3)
    v_mfma_f32_32x32x16_bf16 v[40:55], v[24:27], v[180:183], v[40:55]
    v_permlane16_swap_b32 v105, v107
    v_lshrrev_b32 v112, 1, v112
    ds_read_b128 v[20:23], v5 offset:15360
    v_mfma_f32_32x32x16_bf16 v[56:71], v[28:31], v[180:183], v[56:71]
    v_lshl_add_u32 v112, v113, 4, v112
    v_add_f32 v104, v104, v106
    s_add_u32 s26, s54, 24576
    buffer_load_dwordx4 v[224:227], v1, s[4:7], s26 offen offset:0 sc1
    ds_read_b128 v[24:27], v4 offset:0
    s_waitcnt vmcnt(10) lgkmcnt(3)
    v_mfma_f32_32x32x16_bf16 v[40:55], v[32:35], v[184:187], v[40:55]
    v_add_f32 v105, v105, v107
    v_lshlrev_b32 v112, 2, v112
    ds_read_b128 v[28:31], v4 offset:1024
    v_mfma_f32_32x32x16_bf16 v[56:71], v[36:39], v[184:187], v[56:71]
    v_mov_b32 v106, v104
    v_mov_b32 v107, v105
    buffer_load_dwordx4 v[228:231], v1, s[4:7], s26 offen offset:1024 sc1
    ds_read_b128 v[32:35], v4 offset:2048
    s_waitcnt vmcnt(10) lgkmcnt(3)
    v_mfma_f32_32x32x16_bf16 v[40:55], v[16:19], v[188:191], v[40:55]
    v_permlane32_swap_b32 v104, v106
    v_permlane32_swap_b32 v105, v107
    ds_read_b128 v[36:39], v4 offset:3072
    v_mfma_f32_32x32x16_bf16 v[56:71], v[20:23], v[188:191], v[56:71]
    v_add_f32 v106, v104, v106
    v_add_f32 v107, v105, v107
    s_barrier
    v_add_u32 v5, 98304, v1
    buffer_load_dwordx4 v[232:235], v1, s[4:7], s26 offen offset:2048 sc1
    ds_read_b128 v[16:19], v4 offset:4096
    s_waitcnt vmcnt(10) lgkmcnt(3)
    v_mfma_f32_32x32x16_bf16 v[40:55], v[24:27], v[192:195], v[40:55]
    ds_bpermute_b32 v104, v112, v106
    ds_bpermute_b32 v105, v112, v107
    ds_read_b128 v[20:23], v4 offset:5120
    v_mfma_f32_32x32x16_bf16 v[56:71], v[28:31], v[192:195], v[56:71]
    s_waitcnt lgkmcnt(1)
    v_mul_f32 v104, 0xbb000000, v104
    buffer_load_dwordx4 v[236:239], v1, s[4:7], s26 offen offset:3072 sc1
    ds_read_b128 v[24:27], v4 offset:6144
    s_waitcnt vmcnt(10)
    v_mfma_f32_32x32x16_bf16 v[40:55], v[32:35], v[196:199], v[40:55]
    v_mul_f32 v105, 0x3b000000, v105
    v_fma_f32 v105, -v104, v104, v105
    ds_read_b128 v[28:31], v4 offset:7168
    v_mfma_f32_32x32x16_bf16 v[56:71], v[36:39], v[196:199], v[56:71]
    v_max_f32 v105, 0, v105
    v_add_f32 v121, 0x3727c5ac, v105
    s_add_u32 s26, s54, 28672
    buffer_load_dwordx4 v[240:243], v1, s[4:7], s26 offen offset:0 sc1
    ds_read_b128 v[32:35], v4 offset:8192
    s_waitcnt vmcnt(10) lgkmcnt(3)
    v_mfma_f32_32x32x16_bf16 v[40:55], v[16:19], v[200:203], v[40:55]
    v_rsq_f32 v120, v121
    v_and_b32 v106, s41, v104
    ds_read_b128 v[36:39], v4 offset:9216
    v_mfma_f32_32x32x16_bf16 v[56:71], v[20:23], v[200:203], v[56:71]
    v_sub_f32 v107, v104, v106
    v_lshrrev_b32 v106, 16, v106
    buffer_load_dwordx4 v[244:247], v1, s[4:7], s26 offen offset:1024 sc1
    ds_read_b128 v[16:19], v4 offset:10240
    s_waitcnt vmcnt(10) lgkmcnt(3)
    v_mfma_f32_32x32x16_bf16 v[40:55], v[24:27], v[204:207], v[40:55]
    v_and_or_b32 v106, v107, s41, v106
    v_cmp_gt_u32 vcc, 32, v7
    ds_read_b128 v[20:23], v4 offset:11264
    v_mfma_f32_32x32x16_bf16 v[56:71], v[28:31], v[204:207], v[56:71]
    v_mov_b32 v126, 0
    v_mov_b32 v127, 0
    buffer_load_dwordx4 v[248:251], v1, s[4:7], s26 offen offset:2048 sc1
    ds_read_b128 v[24:27], v4 offset:12288
    s_waitcnt vmcnt(10) lgkmcnt(3)
    v_mfma_f32_32x32x16_bf16 v[40:55], v[32:35], v[208:211], v[40:55]
    v_cndmask_b32 v124, 0, v106, vcc
    ds_read_b128 v[28:31], v4 offset:13312
    v_mfma_f32_32x32x16_bf16 v[56:71], v[36:39], v[208:211], v[56:71]
    v_mov_b32 v125, v124
    buffer_load_dwordx4 v[252:255], v1, s[4:7], s26 offen offset:3072 sc1
    ds_read_b128 v[32:35], v4 offset:14336
    s_waitcnt vmcnt(10) lgkmcnt(3)
    v_mfma_f32_32x32x16_bf16 v[40:55], v[16:19], v[212:215], v[40:55]
    v_mul_f32 v122, 0xc0135761, v120
    ds_read_b128 v[36:39], v4 offset:15360
    v_mfma_f32_32x32x16_bf16 v[56:71], v[20:23], v[212:215], v[56:71]
    v_mul_f32 v123, v120, v120
    ds_read_b128 v[16:19], v5 offset:0
    s_waitcnt vmcnt(9) lgkmcnt(3)
    v_mfma_f32_32x32x16_bf16 v[40:55], v[24:27], v[216:219], v[40:55]
    v_mul_f32 v123, v123, v122
    ds_read_b128 v[20:23], v5 offset:1024
    v_mfma_f32_32x32x16_bf16 v[56:71], v[28:31], v[216:219], v[56:71]
    v_mul_f32 v123, 0x3d372713, v123
    ds_read_b128 v[24:27], v5 offset:2048
    s_waitcnt vmcnt(8) lgkmcnt(3)
    v_mfma_f32_32x32x16_bf16 v[40:55], v[32:35], v[220:223], v[40:55]
    ds_read_b128 v[28:31], v5 offset:3072
    v_mfma_f32_32x32x16_bf16 v[56:71], v[36:39], v[220:223], v[56:71]
    s_barrier
    ds_read_b128 v[32:35], v5 offset:4096
    s_waitcnt vmcnt(7) lgkmcnt(3)
    v_mfma_f32_32x32x16_bf16 v[40:55], v[16:19], v[224:227], v[40:55]
    v_and_b32 v8, 31, v7
    v_lshlrev_b32 v8, 4, v8
    v_add_u32 v8, 148992, v8
    ds_read_b128 v[36:39], v5 offset:5120
    v_mfma_f32_32x32x16_bf16 v[56:71], v[20:23], v[224:227], v[56:71]
    ds_read_b128 v[104:107], v8
    s_waitcnt lgkmcnt(0)
    v_add_f32 v104, v104, v105
    ds_read_b128 v[16:19], v5 offset:6144
    s_waitcnt vmcnt(6)
    v_mfma_f32_32x32x16_bf16 v[40:55], v[24:27], v[228:231], v[40:55]
    v_add_f32 v106, v106, v107
    v_add_f32 v107, v104, v106
    ds_read_b128 v[20:23], v5 offset:7168
    v_mfma_f32_32x32x16_bf16 v[56:71], v[28:31], v[228:231], v[56:71]
    v_and_b32 v8, s41, v107
    v_sub_f32 v107, v107, v8
    ds_read_b128 v[24:27], v5 offset:8192
    s_waitcnt vmcnt(5)
    v_mfma_f32_32x32x16_bf16 v[40:55], v[32:35], v[232:235], v[40:55]
    v_lshrrev_b32 v104, 16, v8
    v_and_b32 v106, s41, v107
    ds_read_b128 v[28:31], v5 offset:9216
    v_mfma_f32_32x32x16_bf16 v[56:71], v[36:39], v[232:235], v[56:71]
    v_or_b32 v104, v104, v8
    v_lshrrev_b32 v105, 16, v106
    ds_read_b128 v[32:35], v5 offset:10240
    s_waitcnt vmcnt(4) lgkmcnt(3)
    v_mfma_f32_32x32x16_bf16 v[40:55], v[16:19], v[236:239], v[40:55]
    v_or_b32 v105, v105, v106
    v_and_b32 v8, 31, v7
    ds_read_b128 v[36:39], v5 offset:11264
    v_mfma_f32_32x32x16_bf16 v[56:71], v[20:23], v[236:239], v[56:71]
    v_lshlrev_b32 v8, 4, v8
    v_add_u32 v8, 149504, v8
    ds_read_b128 v[16:19], v5 offset:12288
    s_waitcnt vmcnt(3) lgkmcnt(3)
    v_mfma_f32_32x32x16_bf16 v[40:55], v[24:27], v[240:243], v[40:55]
    ds_read_b128 v[108:111], v8
    s_waitcnt lgkmcnt(0)
    ds_read_b128 v[20:23], v5 offset:13312
    v_mfma_f32_32x32x16_bf16 v[56:71], v[28:31], v[240:243], v[56:71]
    v_add_f32 v108, v108, v109
    v_add_f32 v110, v110, v111
    ds_read_b128 v[24:27], v5 offset:14336
    s_waitcnt vmcnt(2)
    v_mfma_f32_32x32x16_bf16 v[40:55], v[32:35], v[244:247], v[40:55]
    v_add_f32 v111, v108, v110
    v_and_b32 v8, s41, v111
    ds_read_b128 v[28:31], v5 offset:15360
    v_mfma_f32_32x32x16_bf16 v[56:71], v[36:39], v[244:247], v[56:71]
    v_sub_f32 v111, v111, v8
    v_lshrrev_b32 v108, 16, v8
    s_waitcnt vmcnt(1) lgkmcnt(2)
    v_mfma_f32_32x32x16_bf16 v[40:55], v[16:19], v[248:251], v[40:55]
    v_and_b32 v110, s41, v111
    v_or_b32 v108, v108, v8
    v_mfma_f32_32x32x16_bf16 v[56:71], v[20:23], v[248:251], v[56:71]
    v_lshrrev_b32 v109, 16, v110
    v_or_b32 v109, v109, v110
    s_waitcnt vmcnt(0) lgkmcnt(0)
    v_mfma_f32_32x32x16_bf16 v[40:55], v[24:27], v[252:255], v[40:55]
    v_mfma_f32_32x32x16_bf16 v[56:71], v[28:31], v[252:255], v[56:71]
    v_mfma_f32_32x32x16_bf16 v[40:55], v[104:107], v[124:127], v[40:55]
    v_mfma_f32_32x32x16_bf16 v[56:71], v[108:111], v[124:127], v[56:71]
    v_add_u32 v4, 114688, v1
    v_add_u32 v5, 131072, v1
    s_barrier
    ds_read_b128 v[16:19], v4 offset:0
    ds_read_b128 v[20:23], v4 offset:1024
    ds_read_b128 v[24:27], v4 offset:2048
    ds_read_b128 v[28:31], v4 offset:3072
    ds_read_b128 v[32:35], v4 offset:4096
    s_waitcnt lgkmcnt(3)
    v_mfma_f32_32x32x16_bf16 v[72:87], v[16:19], v[128:131], 0
    ds_read_b128 v[36:39], v4 offset:5120
    v_mfma_f32_32x32x16_bf16 v[88:103], v[20:23], v[128:131], 0
    ds_read_b128 v[16:19], v4 offset:6144
    s_waitcnt lgkmcnt(3)
    v_mfma_f32_32x32x16_bf16 v[72:87], v[24:27], v[132:135], v[72:87]
    v_mul_f32 v112, v40, v40
    v_mul_f32 v113, v41, v41
    v_mul_f32 v114, v42, v42
    ds_read_b128 v[20:23], v4 offset:7168
    v_mfma_f32_32x32x16_bf16 v[88:103], v[28:31], v[132:135], v[88:103]
    v_mul_f32 v115, v43, v43
    v_fma_f32 v112, v112, v123, v122
    v_fma_f32 v113, v113, v123, v122
    ds_read_b128 v[24:27], v4 offset:8192
    s_waitcnt lgkmcnt(3)
    v_mfma_f32_32x32x16_bf16 v[72:87], v[32:35], v[136:139], v[72:87]
    v_fma_f32 v114, v114, v123, v122
    v_fma_f32 v115, v115, v123, v122
    v_mul_f32 v112, v112, v40
    ds_read_b128 v[28:31], v4 offset:9216
    v_mfma_f32_32x32x16_bf16 v[88:103], v[36:39], v[136:139], v[88:103]
    v_mul_f32 v113, v113, v41
    v_mul_f32 v114, v114, v42
    v_mul_f32 v115, v115, v43
    ds_read_b128 v[32:35], v4 offset:10240
    s_waitcnt lgkmcnt(3)
    v_mfma_f32_32x32x16_bf16 v[72:87], v[16:19], v[140:143], v[72:87]
    v_exp_f32 v112, v112
    v_exp_f32 v113, v113
    v_exp_f32 v114, v114
    ds_read_b128 v[36:39], v4 offset:11264
    v_mfma_f32_32x32x16_bf16 v[88:103], v[20:23], v[140:143], v[88:103]
    v_exp_f32 v115, v115
    v_mul_f32 v40, v40, v56
    v_mul_f32 v41, v41, v57
    ds_read_b128 v[16:19], v4 offset:12288
    s_waitcnt lgkmcnt(3)
    v_mfma_f32_32x32x16_bf16 v[72:87], v[24:27], v[144:147], v[72:87]
    v_mul_f32 v42, v42, v58
    v_mul_f32 v43, v43, v59
    v_fma_f32 v112, v112, v121, v121
    ds_read_b128 v[20:23], v4 offset:13312
    v_mfma_f32_32x32x16_bf16 v[88:103], v[28:31], v[144:147], v[88:103]
    v_fma_f32 v113, v113, v121, v121
    v_fma_f32 v114, v114, v121, v121
    v_fma_f32 v115, v115, v121, v121
    ds_read_b128 v[24:27], v4 offset:14336
    s_waitcnt lgkmcnt(3)
    v_mfma_f32_32x32x16_bf16 v[72:87], v[32:35], v[148:151], v[72:87]
    v_rcp_f32 v112, v112
    v_rcp_f32 v113, v113
    v_rcp_f32 v114, v114
    ds_read_b128 v[28:31], v4 offset:15360
    v_mfma_f32_32x32x16_bf16 v[88:103], v[36:39], v[148:151], v[88:103]
    v_rcp_f32 v115, v115
    v_mul_f32 v112, v112, v40
    v_mul_f32 v113, v113, v41
    ds_read_b128 v[32:35], v5 offset:0
    s_waitcnt lgkmcnt(3)
    v_mfma_f32_32x32x16_bf16 v[72:87], v[16:19], v[152:155], v[72:87]
    v_mul_f32 v114, v114, v42
    v_mul_f32 v115, v115, v43
    v_cvt_pk_bf16_f32 v40, v112, v113
    ds_read_b128 v[36:39], v5 offset:1024
    v_mfma_f32_32x32x16_bf16 v[88:103], v[20:23], v[152:155], v[88:103]
    v_cvt_pk_bf16_f32 v41, v114, v115
    v_mul_f32 v116, v44, v44
    v_mul_f32 v117, v45, v45
    ds_read_b128 v[16:19], v5 offset:2048
    s_waitcnt lgkmcnt(3)
    v_mfma_f32_32x32x16_bf16 v[72:87], v[24:27], v[156:159], v[72:87]
    v_mul_f32 v118, v46, v46
    v_mul_f32 v119, v47, v47
    v_fma_f32 v116, v116, v123, v122
    ds_read_b128 v[20:23], v5 offset:3072
    v_mfma_f32_32x32x16_bf16 v[88:103], v[28:31], v[156:159], v[88:103]
    v_fma_f32 v117, v117, v123, v122
    v_fma_f32 v118, v118, v123, v122
    v_fma_f32 v119, v119, v123, v122
    s_barrier
    v_add_u32 v4, 98304, v1
    ds_read_b128 v[24:27], v5 offset:4096
    s_waitcnt lgkmcnt(3)
    v_mfma_f32_32x32x16_bf16 v[72:87], v[32:35], v[160:163], v[72:87]
    v_mul_f32 v116, v116, v44
    v_mul_f32 v117, v117, v45
    v_mul_f32 v118, v118, v46
    ds_read_b128 v[28:31], v5 offset:5120
    v_mfma_f32_32x32x16_bf16 v[88:103], v[36:39], v[160:163], v[88:103]
    v_mul_f32 v119, v119, v47
    v_exp_f32 v116, v116
    v_exp_f32 v117, v117
    ds_read_b128 v[32:35], v5 offset:6144
    s_waitcnt lgkmcnt(3)
    v_mfma_f32_32x32x16_bf16 v[72:87], v[16:19], v[164:167], v[72:87]
    v_exp_f32 v118, v118
    v_exp_f32 v119, v119
    v_mul_f32 v44, v44, v60
    ds_read_b128 v[36:39], v5 offset:7168
    v_mfma_f32_32x32x16_bf16 v[88:103], v[20:23], v[164:167], v[88:103]
    v_mul_f32 v45, v45, v61
    v_mul_f32 v46, v46, v62
    v_mul_f32 v47, v47, v63
    ds_read_b128 v[16:19], v5 offset:8192
    s_waitcnt lgkmcnt(3)
    v_mfma_f32_32x32x16_bf16 v[72:87], v[24:27], v[168:171], v[72:87]
    v_fma_f32 v116, v116, v121, v121
    v_fma_f32 v117, v117, v121, v121
    v_fma_f32 v118, v118, v121, v121
    ds_read_b128 v[20:23], v5 offset:9216
    v_mfma_f32_32x32x16_bf16 v[88:103], v[28:31], v[168:171], v[88:103]
    v_fma_f32 v119, v119, v121, v121
    v_rcp_f32 v116, v116
    v_rcp_f32 v117, v117
    ds_read_b128 v[24:27], v5 offset:10240
    s_waitcnt lgkmcnt(3)
    v_mfma_f32_32x32x16_bf16 v[72:87], v[32:35], v[172:175], v[72:87]
    v_rcp_f32 v118, v118
    v_rcp_f32 v119, v119
    v_mul_f32 v116, v116, v44
    ds_read_b128 v[28:31], v5 offset:11264
    v_mfma_f32_32x32x16_bf16 v[88:103], v[36:39], v[172:175], v[88:103]
    v_mul_f32 v117, v117, v45
    v_mul_f32 v118, v118, v46
    v_mul_f32 v119, v119, v47
    ds_read_b128 v[32:35], v5 offset:12288
    s_waitcnt lgkmcnt(3)
    v_mfma_f32_32x32x16_bf16 v[72:87], v[16:19], v[176:179], v[72:87]
    v_cvt_pk_bf16_f32 v42, v116, v117
    v_cvt_pk_bf16_f32 v43, v118, v119
    v_mul_f32 v112, v48, v48
    ds_read_b128 v[36:39], v5 offset:13312
    v_mfma_f32_32x32x16_bf16 v[88:103], v[20:23], v[176:179], v[88:103]
    v_mul_f32 v113, v49, v49
    v_mul_f32 v114, v50, v50
    v_mul_f32 v115, v51, v51
    ds_read_b128 v[16:19], v5 offset:14336
    s_waitcnt lgkmcnt(3)
    v_mfma_f32_32x32x16_bf16 v[72:87], v[24:27], v[180:183], v[72:87]
    v_fma_f32 v112, v112, v123, v122
    v_fma_f32 v113, v113, v123, v122
    v_fma_f32 v114, v114, v123, v122
    ds_read_b128 v[20:23], v5 offset:15360
    v_mfma_f32_32x32x16_bf16 v[88:103], v[28:31], v[180:183], v[88:103]
    v_fma_f32 v115, v115, v123, v122
    v_mul_f32 v112, v112, v48
    v_mul_f32 v113, v113, v49
    ds_read_b128 v[24:27], v4 offset:0
    s_waitcnt lgkmcnt(3)
    v_mfma_f32_32x32x16_bf16 v[72:87], v[32:35], v[184:187], v[72:87]
    v_mul_f32 v114, v114, v50
    v_mul_f32 v115, v115, v51
    v_exp_f32 v112, v112
    ds_read_b128 v[28:31], v4 offset:1024
    v_mfma_f32_32x32x16_bf16 v[88:103], v[36:39], v[184:187], v[88:103]
    v_exp_f32 v113, v113
    v_exp_f32 v114, v114
    v_exp_f32 v115, v115
    ds_read_b128 v[32:35], v4 offset:2048
    s_waitcnt lgkmcnt(3)
    v_mfma_f32_32x32x16_bf16 v[72:87], v[16:19], v[188:191], v[72:87]
    v_mul_f32 v48, v48, v64
    v_mul_f32 v49, v49, v65
    v_mul_f32 v50, v50, v66
    ds_read_b128 v[36:39], v4 offset:3072
    v_mfma_f32_32x32x16_bf16 v[88:103], v[20:23], v[188:191], v[88:103]
    v_mul_f32 v51, v51, v67
    v_fma_f32 v112, v112, v121, v121
    v_fma_f32 v113, v113, v121, v121
    s_barrier
    v_add_u32 v5, 114688, v1
    ds_read_b128 v[16:19], v4 offset:4096
    s_waitcnt lgkmcnt(3)
    v_mfma_f32_32x32x16_bf16 v[72:87], v[24:27], v[192:195], v[72:87]
    v_fma_f32 v114, v114, v121, v121
    v_fma_f32 v115, v115, v121, v121
    v_rcp_f32 v112, v112
    ds_read_b128 v[20:23], v4 offset:5120
    v_mfma_f32_32x32x16_bf16 v[88:103], v[28:31], v[192:195], v[88:103]
    v_rcp_f32 v113, v113
    v_rcp_f32 v114, v114
    v_rcp_f32 v115, v115
    ds_read_b128 v[24:27], v4 offset:6144
    s_waitcnt lgkmcnt(3)
    v_mfma_f32_32x32x16_bf16 v[72:87], v[32:35], v[196:199], v[72:87]
    v_mul_f32 v112, v112, v48
    v_mul_f32 v113, v113, v49
    v_mul_f32 v114, v114, v50
    v_and_b32 v8, 31, v7
    v_lshlrev_b32 v8, 4, v8
    ds_read_b128 v[28:31], v4 offset:7168
    v_mfma_f32_32x32x16_bf16 v[88:103], v[36:39], v[196:199], v[88:103]
    v_mul_f32 v115, v115, v51
    v_cvt_pk_bf16_f32 v44, v112, v113
    v_add_u32 v8, 150016, v8
    ds_read_b128 v[104:107], v8
    ds_read_b128 v[32:35], v4 offset:8192
    s_waitcnt lgkmcnt(4)
    v_mfma_f32_32x32x16_bf16 v[72:87], v[16:19], v[200:203], v[72:87]
    v_cvt_pk_bf16_f32 v45, v114, v115
    v_mul_f32 v116, v52, v52
    s_waitcnt lgkmcnt(1)
    v_add_f32 v104, v104, v105
    ds_read_b128 v[36:39], v4 offset:9216
    v_mfma_f32_32x32x16_bf16 v[88:103], v[20:23], v[200:203], v[88:103]
    v_mul_f32 v117, v53, v53
    v_mul_f32 v118, v54, v54
    v_add_f32 v106, v106, v107
    v_add_f32 v107, v104, v106
    ds_read_b128 v[16:19], v4 offset:10240
    v_mfma_f32_32x32x16_bf16 v[72:87], v[24:27], v[204:207], v[72:87]
    v_mul_f32 v119, v55, v55
    v_fma_f32 v116, v116, v123, v122
    v_and_b32 v8, s41, v107
    ds_read_b128 v[20:23], v4 offset:11264
    v_mfma_f32_32x32x16_bf16 v[88:103], v[28:31], v[204:207], v[88:103]
    v_fma_f32 v117, v117, v123, v122
    v_fma_f32 v118, v118, v123, v122
    v_sub_f32 v107, v107, v8
    ds_read_b128 v[24:27], v4 offset:12288
    s_waitcnt lgkmcnt(3)
    v_mfma_f32_32x32x16_bf16 v[72:87], v[32:35], v[208:211], v[72:87]
    v_fma_f32 v119, v119, v123, v122
    v_mul_f32 v116, v116, v52
    v_lshrrev_b32 v104, 16, v8
    ds_read_b128 v[28:31], v4 offset:13312
    v_mfma_f32_32x32x16_bf16 v[88:103], v[36:39], v[208:211], v[88:103]
    v_mul_f32 v117, v117, v53
    v_mul_f32 v118, v118, v54
    v_and_b32 v106, s41, v107
    ds_read_b128 v[32:35], v4 offset:14336
    s_waitcnt lgkmcnt(3)
    v_mfma_f32_32x32x16_bf16 v[72:87], v[16:19], v[212:215], v[72:87]
    v_mul_f32 v119, v119, v55
    v_exp_f32 v116, v116
    v_or_b32 v104, v104, v8
    ds_read_b128 v[36:39], v4 offset:15360
    v_mfma_f32_32x32x16_bf16 v[88:103], v[20:23], v[212:215], v[88:103]
    v_exp_f32 v117, v117
    v_exp_f32 v118, v118
    v_lshrrev_b32 v105, 16, v106
    ds_read_b128 v[16:19], v5 offset:0
    s_waitcnt lgkmcnt(3)
    v_mfma_f32_32x32x16_bf16 v[72:87], v[24:27], v[216:219], v[72:87]
    v_exp_f32 v119, v119
    v_mul_f32 v52, v52, v68
    v_or_b32 v105, v105, v106
    ds_read_b128 v[20:23], v5 offset:1024
    v_mfma_f32_32x32x16_bf16 v[88:103], v[28:31], v[216:219], v[88:103]
    v_mul_f32 v53, v53, v69
    v_mul_f32 v54, v54, v70
    v_and_b32 v8, 31, v7
    ds_read_b128 v[24:27], v5 offset:2048
    s_waitcnt lgkmcnt(3)
    v_mfma_f32_32x32x16_bf16 v[72:87], v[32:35], v[220:223], v[72:87]
    v_mul_f32 v55, v55, v71
    v_fma_f32 v116, v116, v121, v121
    v_lshlrev_b32 v8, 4, v8
    ds_read_b128 v[28:31], v5 offset:3072
    v_mfma_f32_32x32x16_bf16 v[88:103], v[36:39], v[220:223], v[88:103]
    v_fma_f32 v117, v117, v121, v121
    v_fma_f32 v118, v118, v121, v121
    v_add_u32 v8, 150528, v8
    s_barrier
    ds_read_b128 v[32:35], v5 offset:4096
    s_waitcnt lgkmcnt(3)
    v_mfma_f32_32x32x16_bf16 v[72:87], v[16:19], v[224:227], v[72:87]
    v_fma_f32 v119, v119, v121, v121
    v_rcp_f32 v116, v116
    ds_read_b128 v[108:111], v8
    ds_read_b128 v[36:39], v5 offset:5120
    v_mfma_f32_32x32x16_bf16 v[88:103], v[20:23], v[224:227], v[88:103]
    v_rcp_f32 v117, v117
    v_rcp_f32 v118, v118
    s_waitcnt lgkmcnt(1)
    ds_read_b128 v[16:19], v5 offset:6144
    v_mfma_f32_32x32x16_bf16 v[72:87], v[24:27], v[228:231], v[72:87]
    v_rcp_f32 v119, v119
    v_mul_f32 v116, v116, v52
    v_add_f32 v108, v108, v109
    ds_read_b128 v[20:23], v5 offset:7168
    v_mfma_f32_32x32x16_bf16 v[88:103], v[28:31], v[228:231], v[88:103]
    v_mul_f32 v117, v117, v53
    v_mul_f32 v118, v118, v54
    v_add_f32 v110, v110, v111
    ds_read_b128 v[24:27], v5 offset:8192
    s_waitcnt lgkmcnt(3)
    v_mfma_f32_32x32x16_bf16 v[72:87], v[32:35], v[232:235], v[72:87]
    v_mul_f32 v119, v119, v55
    v_cvt_pk_bf16_f32 v46, v116, v117
    v_add_f32 v111, v108, v110
    ds_read_b128 v[28:31], v5 offset:9216
    v_mfma_f32_32x32x16_bf16 v[88:103], v[36:39], v[232:235], v[88:103]
    v_cvt_pk_bf16_f32 v47, v118, v119
    s_mul_i32 s28, s17, 3
    s_cmp_gt_u32 s28, 42
    s_cselect_b32 s28, 0xfe000, s28
    s_lshl_b32 s28, s28, 11
    s_add_u32 s28, s28, s56
    buffer_store_dwordx4 v[40:43], v1, s[4:7], s28 offen
    buffer_store_dwordx4 v[44:47], v1, s[4:7], s28 offen offset:1024
    v_and_b32 v8, s41, v111
    ds_read_b128 v[32:35], v5 offset:10240
    s_waitcnt lgkmcnt(3)
    v_mfma_f32_32x32x16_bf16 v[72:87], v[16:19], v[236:239], v[72:87]
    v_sub_f32 v111, v111, v8
    ds_read_b128 v[36:39], v5 offset:11264
    v_mfma_f32_32x32x16_bf16 v[88:103], v[20:23], v[236:239], v[88:103]
    v_lshrrev_b32 v108, 16, v8
    ds_read_b128 v[16:19], v5 offset:12288
    s_waitcnt lgkmcnt(3)
    v_mfma_f32_32x32x16_bf16 v[72:87], v[24:27], v[240:243], v[72:87]
    v_and_b32 v110, s41, v111
    ds_read_b128 v[20:23], v5 offset:13312
    v_mfma_f32_32x32x16_bf16 v[88:103], v[28:31], v[240:243], v[88:103]
    v_or_b32 v108, v108, v8
    ds_read_b128 v[24:27], v5 offset:14336
    s_waitcnt lgkmcnt(3)
    v_mfma_f32_32x32x16_bf16 v[72:87], v[32:35], v[244:247], v[72:87]
    v_lshrrev_b32 v109, 16, v110
    ds_read_b128 v[28:31], v5 offset:15360
    v_mfma_f32_32x32x16_bf16 v[88:103], v[36:39], v[244:247], v[88:103]
    v_or_b32 v109, v109, v110
    s_waitcnt lgkmcnt(2)
    v_mfma_f32_32x32x16_bf16 v[72:87], v[16:19], v[248:251], v[72:87]
    v_mfma_f32_32x32x16_bf16 v[88:103], v[20:23], v[248:251], v[88:103]
    s_waitcnt lgkmcnt(0)
    v_mfma_f32_32x32x16_bf16 v[72:87], v[24:27], v[252:255], v[72:87]
    v_mfma_f32_32x32x16_bf16 v[88:103], v[28:31], v[252:255], v[88:103]
    v_mfma_f32_32x32x16_bf16 v[72:87], v[104:107], v[124:127], v[72:87]
    v_mfma_f32_32x32x16_bf16 v[88:103], v[108:111], v[124:127], v[88:103]
    v_add_u32 v4, 131072, v1
    v_add_u32 v5, 98304, v1
    s_barrier
    ds_read_b128 v[16:19], v4 offset:0
    ds_read_b128 v[20:23], v4 offset:1024
    ds_read_b128 v[24:27], v4 offset:2048
    ds_read_b128 v[28:31], v4 offset:3072
    ds_read_b128 v[32:35], v4 offset:4096
    s_waitcnt lgkmcnt(3)
    v_mfma_f32_32x32x16_bf16 v[40:55], v[16:19], v[128:131], 0
    ds_read_b128 v[36:39], v4 offset:5120
    v_mfma_f32_32x32x16_bf16 v[56:71], v[20:23], v[128:131], 0
    ds_read_b128 v[16:19], v4 offset:6144
    s_waitcnt lgkmcnt(3)
    v_mfma_f32_32x32x16_bf16 v[40:55], v[24:27], v[132:135], v[40:55]
    v_mul_f32 v112, v72, v72
    v_mul_f32 v113, v73, v73
    v_mul_f32 v114, v74, v74
    ds_read_b128 v[20:23], v4 offset:7168
    v_mfma_f32_32x32x16_bf16 v[56:71], v[28:31], v[132:135], v[56:71]
    v_mul_f32 v115, v75, v75
    v_fma_f32 v112, v112, v123, v122
    v_fma_f32 v113, v113, v123, v122
    ds_read_b128 v[24:27], v4 offset:8192
    s_waitcnt lgkmcnt(3)
    v_mfma_f32_32x32x16_bf16 v[40:55], v[32:35], v[136:139], v[40:55]
    v_fma_f32 v114, v114, v123, v122
    v_fma_f32 v115, v115, v123, v122
    v_mul_f32 v112, v112, v72
    ds_read_b128 v[28:31], v4 offset:9216
    v_mfma_f32_32x32x16_bf16 v[56:71], v[36:39], v[136:139], v[56:71]
    v_mul_f32 v113, v113, v73
    v_mul_f32 v114, v114, v74
    v_mul_f32 v115, v115, v75
    ds_read_b128 v[32:35], v4 offset:10240
    s_waitcnt lgkmcnt(3)
    v_mfma_f32_32x32x16_bf16 v[40:55], v[16:19], v[140:143], v[40:55]
    v_exp_f32 v112, v112
    v_exp_f32 v113, v113
    v_exp_f32 v114, v114
    ds_read_b128 v[36:39], v4 offset:11264
    v_mfma_f32_32x32x16_bf16 v[56:71], v[20:23], v[140:143], v[56:71]
    v_exp_f32 v115, v115
    v_mul_f32 v72, v72, v88
    v_mul_f32 v73, v73, v89
    ds_read_b128 v[16:19], v4 offset:12288
    s_waitcnt lgkmcnt(3)
    v_mfma_f32_32x32x16_bf16 v[40:55], v[24:27], v[144:147], v[40:55]
    v_mul_f32 v74, v74, v90
    v_mul_f32 v75, v75, v91
    v_fma_f32 v112, v112, v121, v121
    ds_read_b128 v[20:23], v4 offset:13312
    v_mfma_f32_32x32x16_bf16 v[56:71], v[28:31], v[144:147], v[56:71]
    v_fma_f32 v113, v113, v121, v121
    v_fma_f32 v114, v114, v121, v121
    v_fma_f32 v115, v115, v121, v121
    ds_read_b128 v[24:27], v4 offset:14336
    s_waitcnt lgkmcnt(3)
    v_mfma_f32_32x32x16_bf16 v[40:55], v[32:35], v[148:151], v[40:55]
    v_rcp_f32 v112, v112
    v_rcp_f32 v113, v113
    v_rcp_f32 v114, v114
    ds_read_b128 v[28:31], v4 offset:15360
    v_mfma_f32_32x32x16_bf16 v[56:71], v[36:39], v[148:151], v[56:71]
    v_rcp_f32 v115, v115
    v_mul_f32 v112, v112, v72
    v_mul_f32 v113, v113, v73
    ds_read_b128 v[32:35], v5 offset:0
    s_waitcnt lgkmcnt(3)
    v_mfma_f32_32x32x16_bf16 v[40:55], v[16:19], v[152:155], v[40:55]
    v_mul_f32 v114, v114, v74
    v_mul_f32 v115, v115, v75
    v_cvt_pk_bf16_f32 v72, v112, v113
    s_add_u32 s20, s20, 16
    v_mov_b32 v11, 0
    v_mov_b32 v12, s20
    s_waitcnt vmcnt(0)
    s_cmp_lg_u32 s19, 0
    s_cbranch_scc1 Lsg27
    s_mov_b64 exec, 1
    buffer_store_dword v12, v11, s[4:7], s51 offen
    s_mov_b64 exec, -1
Lsb28:
    ds_read_b128 v[36:39], v5 offset:1024
    v_mfma_f32_32x32x16_bf16 v[56:71], v[20:23], v[152:155], v[56:71]
    v_cvt_pk_bf16_f32 v73, v114, v115
    v_mul_f32 v116, v76, v76
    v_mul_f32 v117, v77, v77
    ds_read_b128 v[16:19], v5 offset:2048
    s_waitcnt lgkmcnt(3)
    v_mfma_f32_32x32x16_bf16 v[40:55], v[24:27], v[156:159], v[40:55]
    v_mul_f32 v118, v78, v78
    v_mul_f32 v119, v79, v79
    v_fma_f32 v116, v116, v123, v122
    ds_read_b128 v[20:23], v5 offset:3072
    v_mfma_f32_32x32x16_bf16 v[56:71], v[28:31], v[156:159], v[56:71]
    v_fma_f32 v117, v117, v123, v122
    v_fma_f32 v118, v118, v123, v122
    v_fma_f32 v119, v119, v123, v122
    s_barrier
    v_add_u32 v4, 114688, v1
    ds_read_b128 v[24:27], v5 offset:4096
    s_waitcnt lgkmcnt(3)
    v_mfma_f32_32x32x16_bf16 v[40:55], v[32:35], v[160:163], v[40:55]
    v_mul_f32 v116, v116, v76
    v_mul_f32 v117, v117, v77
    v_mul_f32 v118, v118, v78
    ds_read_b128 v[28:31], v5 offset:5120
    v_mfma_f32_32x32x16_bf16 v[56:71], v[36:39], v[160:163], v[56:71]
    v_mul_f32 v119, v119, v79
    v_exp_f32 v116, v116
    v_exp_f32 v117, v117
    ds_read_b128 v[32:35], v5 offset:6144
    s_waitcnt lgkmcnt(3)
    v_mfma_f32_32x32x16_bf16 v[40:55], v[16:19], v[164:167], v[40:55]
    v_exp_f32 v118, v118
    v_exp_f32 v119, v119
    v_mul_f32 v76, v76, v92
    ds_read_b128 v[36:39], v5 offset:7168
    v_mfma_f32_32x32x16_bf16 v[56:71], v[20:23], v[164:167], v[56:71]
    v_mul_f32 v77, v77, v93
    v_mul_f32 v78, v78, v94
    v_mul_f32 v79, v79, v95
    ds_read_b128 v[16:19], v5 offset:8192
    s_waitcnt lgkmcnt(3)
    v_mfma_f32_32x32x16_bf16 v[40:55], v[24:27], v[168:171], v[40:55]
    v_fma_f32 v116, v116, v121, v121
    v_fma_f32 v117, v117, v121, v121
    v_fma_f32 v118, v118, v121, v121
    ds_read_b128 v[20:23], v5 offset:9216
    v_mfma_f32_32x32x16_bf16 v[56:71], v[28:31], v[168:171], v[56:71]
    v_fma_f32 v119, v119, v121, v121
    v_rcp_f32 v116, v116
    v_rcp_f32 v117, v117
    ds_read_b128 v[24:27], v5 offset:10240
    s_waitcnt lgkmcnt(3)
    v_mfma_f32_32x32x16_bf16 v[40:55], v[32:35], v[172:175], v[40:55]
    v_rcp_f32 v118, v118
    v_rcp_f32 v119, v119
    v_mul_f32 v116, v116, v76
    ds_read_b128 v[28:31], v5 offset:11264
    v_mfma_f32_32x32x16_bf16 v[56:71], v[36:39], v[172:175], v[56:71]
    v_mul_f32 v117, v117, v77
    v_mul_f32 v118, v118, v78
    v_mul_f32 v119, v119, v79
    ds_read_b128 v[32:35], v5 offset:12288
    s_waitcnt lgkmcnt(3)
    v_mfma_f32_32x32x16_bf16 v[40:55], v[16:19], v[176:179], v[40:55]
    v_cvt_pk_bf16_f32 v74, v116, v117
    v_cvt_pk_bf16_f32 v75, v118, v119
    v_mul_f32 v112, v80, v80
    ds_read_b128 v[36:39], v5 offset:13312
    v_mfma_f32_32x32x16_bf16 v[56:71], v[20:23], v[176:179], v[56:71]
    v_mul_f32 v113, v81, v81
    v_mul_f32 v114, v82, v82
    v_mul_f32 v115, v83, v83
    ds_read_b128 v[16:19], v5 offset:14336
    s_waitcnt lgkmcnt(3)
    v_mfma_f32_32x32x16_bf16 v[40:55], v[24:27], v[180:183], v[40:55]
    v_fma_f32 v112, v112, v123, v122
    v_fma_f32 v113, v113, v123, v122
    v_fma_f32 v114, v114, v123, v122
    ds_read_b128 v[20:23], v5 offset:15360
    v_mfma_f32_32x32x16_bf16 v[56:71], v[28:31], v[180:183], v[56:71]
    v_fma_f32 v115, v115, v123, v122
    v_mul_f32 v112, v112, v80
    v_mul_f32 v113, v113, v81
    ds_read_b128 v[24:27], v4 offset:0
    s_waitcnt lgkmcnt(3)
    v_mfma_f32_32x32x16_bf16 v[40:55], v[32:35], v[184:187], v[40:55]
    v_mul_f32 v114, v114, v82
    v_mul_f32 v115, v115, v83
    v_exp_f32 v112, v112
    ds_read_b128 v[28:31], v4 offset:1024
    v_mfma_f32_32x32x16_bf16 v[56:71], v[36:39], v[184:187], v[56:71]
    v_exp_f32 v113, v113
    v_exp_f32 v114, v114
    v_exp_f32 v115, v115
    ds_read_b128 v[32:35], v4 offset:2048
    s_waitcnt lgkmcnt(3)
    v_mfma_f32_32x32x16_bf16 v[40:55], v[16:19], v[188:191], v[40:55]
    v_mul_f32 v80, v80, v96
    v_mul_f32 v81, v81, v97
    v_mul_f32 v82, v82, v98
    ds_read_b128 v[36:39], v4 offset:3072
    v_mfma_f32_32x32x16_bf16 v[56:71], v[20:23], v[188:191], v[56:71]
    v_mul_f32 v83, v83, v99
    v_fma_f32 v112, v112, v121, v121
    v_fma_f32 v113, v113, v121, v121
    s_barrier
    v_add_u32 v5, 131072, v1
    ds_read_b128 v[16:19], v4 offset:4096
    s_waitcnt lgkmcnt(3)
    v_mfma_f32_32x32x16_bf16 v[40:55], v[24:27], v[192:195], v[40:55]
    v_fma_f32 v114, v114, v121, v121
    v_fma_f32 v115, v115, v121, v121
    v_rcp_f32 v112, v112
    ds_read_b128 v[20:23], v4 offset:5120
    v_mfma_f32_32x32x16_bf16 v[56:71], v[28:31], v[192:195], v[56:71]
    v_rcp_f32 v113, v113
    v_rcp_f32 v114, v114
    v_rcp_f32 v115, v115
    ds_read_b128 v[24:27], v4 offset:6144
    s_waitcnt lgkmcnt(3)
    v_mfma_f32_32x32x16_bf16 v[40:55], v[32:35], v[196:199], v[40:55]
    v_mul_f32 v112, v112, v80
    v_mul_f32 v113, v113, v81
    v_mul_f32 v114, v114, v82
    v_and_b32 v8, 31, v7
    v_lshlrev_b32 v8, 4, v8
    ds_read_b128 v[28:31], v4 offset:7168
    v_mfma_f32_32x32x16_bf16 v[56:71], v[36:39], v[196:199], v[56:71]
    v_mul_f32 v115, v115, v83
    v_cvt_pk_bf16_f32 v76, v112, v113
    v_add_u32 v8, 151040, v8
    ds_read_b128 v[104:107], v8
    ds_read_b128 v[32:35], v4 offset:8192
    s_waitcnt lgkmcnt(4)
    v_mfma_f32_32x32x16_bf16 v[40:55], v[16:19], v[200:203], v[40:55]
    v_cvt_pk_bf16_f32 v77, v114, v115
    v_mul_f32 v116, v84, v84
    s_waitcnt lgkmcnt(1)
    v_add_f32 v104, v104, v105
    ds_read_b128 v[36:39], v4 offset:9216
    v_mfma_f32_32x32x16_bf16 v[56:71], v[20:23], v[200:203], v[56:71]
    v_mul_f32 v117, v85, v85
    v_mul_f32 v118, v86, v86
    v_add_f32 v106, v106, v107
    v_add_f32 v107, v104, v106
    ds_read_b128 v[16:19], v4 offset:10240
    v_mfma_f32_32x32x16_bf16 v[40:55], v[24:27], v[204:207], v[40:55]
    v_mul_f32 v119, v87, v87
    v_fma_f32 v116, v116, v123, v122
    v_and_b32 v8, s41, v107
    ds_read_b128 v[20:23], v4 offset:11264
    v_mfma_f32_32x32x16_bf16 v[56:71], v[28:31], v[204:207], v[56:71]
    v_fma_f32 v117, v117, v123, v122
    v_fma_f32 v118, v118, v123, v122
    v_sub_f32 v107, v107, v8
    ds_read_b128 v[24:27], v4 offset:12288
    s_waitcnt lgkmcnt(3)
    v_mfma_f32_32x32x16_bf16 v[40:55], v[32:35], v[208:211], v[40:55]
    v_fma_f32 v119, v119, v123, v122
    v_mul_f32 v116, v116, v84
    v_lshrrev_b32 v104, 16, v8
    buffer_load_dword v13, v6, s[4:7], s44 offen sc1
    ds_read_b128 v[28:31], v4 offset:13312
    v_mfma_f32_32x32x16_bf16 v[56:71], v[36:39], v[208:211], v[56:71]
    v_mul_f32 v117, v117, v85
    v_mul_f32 v118, v118, v86
    v_and_b32 v106, s41, v107
    ds_read_b128 v[32:35], v4 offset:14336
    s_waitcnt lgkmcnt(3)
    v_mfma_f32_32x32x16_bf16 v[40:55], v[16:19], v[212:215], v[40:55]
    v_mul_f32 v119, v119, v87
    v_exp_f32 v116, v116
    v_or_b32 v104, v104, v8
    ds_read_b128 v[36:39], v4 offset:15360
    v_mfma_f32_32x32x16_bf16 v[56:71], v[20:23], v[212:215], v[56:71]
    v_exp_f32 v117, v117
    v_exp_f32 v118, v118
    v_lshrrev_b32 v105, 16, v106
    ds_read_b128 v[16:19], v5 offset:0
    s_waitcnt lgkmcnt(3)
    v_mfma_f32_32x32x16_bf16 v[40:55], v[24:27], v[216:219], v[40:55]
    v_exp_f32 v119, v119
    v_mul_f32 v84, v84, v100
    v_or_b32 v105, v105, v106
    ds_read_b128 v[20:23], v5 offset:1024
    v_mfma_f32_32x32x16_bf16 v[56:71], v[28:31], v[216:219], v[56:71]
    v_mul_f32 v85, v85, v101
    v_mul_f32 v86, v86, v102
    v_and_b32 v8, 31, v7
    ds_read_b128 v[24:27], v5 offset:2048
    s_waitcnt lgkmcnt(3)
    v_mfma_f32_32x32x16_bf16 v[40:55], v[32:35], v[220:223], v[40:55]
    v_mul_f32 v87, v87, v103
    v_fma_f32 v116, v116, v121, v121
    v_lshlrev_b32 v8, 4, v8
    ds_read_b128 v[28:31], v5 offset:3072
    v_mfma_f32_32x32x16_bf16 v[56:71], v[36:39], v[220:223], v[56:71]
    v_fma_f32 v117, v117, v121, v121
    v_fma_f32 v118, v118, v121, v121
    v_add_u32 v8, 151552, v8
    s_barrier
    ds_read_b128 v[32:35], v5 offset:4096
    s_waitcnt lgkmcnt(3)
    v_mfma_f32_32x32x16_bf16 v[40:55], v[16:19], v[224:227], v[40:55]
    v_fma_f32 v119, v119, v121, v121
    v_rcp_f32 v116, v116
    ds_read_b128 v[108:111], v8
    ds_read_b128 v[36:39], v5 offset:5120
    v_mfma_f32_32x32x16_bf16 v[56:71], v[20:23], v[224:227], v[56:71]
    v_rcp_f32 v117, v117
    v_rcp_f32 v118, v118
    s_waitcnt lgkmcnt(1)
    ds_read_b128 v[16:19], v5 offset:6144
    v_mfma_f32_32x32x16_bf16 v[40:55], v[24:27], v[228:231], v[40:55]
    v_rcp_f32 v119, v119
    v_mul_f32 v116, v116, v84
    v_add_f32 v108, v108, v109
    ds_read_b128 v[20:23], v5 offset:7168
    v_mfma_f32_32x32x16_bf16 v[56:71], v[28:31], v[228:231], v[56:71]
    v_mul_f32 v117, v117, v85
    v_mul_f32 v118, v118, v86
    v_add_f32 v110, v110, v111
    ds_read_b128 v[24:27], v5 offset:8192
    s_waitcnt lgkmcnt(3)
    v_mfma_f32_32x32x16_bf16 v[40:55], v[32:35], v[232:235], v[40:55]
    v_mul_f32 v119, v119, v87
    v_cvt_pk_bf16_f32 v78, v116, v117
    v_add_f32 v111, v108, v110
    ds_read_b128 v[28:31], v5 offset:9216
    v_mfma_f32_32x32x16_bf16 v[56:71], v[36:39], v[232:235], v[56:71]
    v_cvt_pk_bf16_f32 v79, v118, v119
    s_mul_i32 s28, s17, 3
    s_add_u32 s28, s28, 1
    s_cmp_gt_u32 s28, 42
    s_cselect_b32 s28, 0xfe000, s28
    s_lshl_b32 s28, s28, 11
    s_add_u32 s28, s28, s56
    buffer_store_dwordx4 v[72:75], v1, s[4:7], s28 offen
    buffer_store_dwordx4 v[76:79], v1, s[4:7], s28 offen offset:1024
    v_and_b32 v8, s41, v111
    ds_read_b128 v[32:35], v5 offset:10240
    s_waitcnt lgkmcnt(3)
    v_mfma_f32_32x32x16_bf16 v[40:55], v[16:19], v[236:239], v[40:55]
    v_sub_f32 v111, v111, v8
    ds_read_b128 v[36:39], v5 offset:11264
    v_mfma_f32_32x32x16_bf16 v[56:71], v[20:23], v[236:239], v[56:71]
    v_lshrrev_b32 v108, 16, v8
    ds_read_b128 v[16:19], v5 offset:12288
    s_waitcnt lgkmcnt(3)
    v_mfma_f32_32x32x16_bf16 v[40:55], v[24:27], v[240:243], v[40:55]
    v_and_b32 v110, s41, v111
    ds_read_b128 v[20:23], v5 offset:13312
    v_mfma_f32_32x32x16_bf16 v[56:71], v[28:31], v[240:243], v[56:71]
    v_or_b32 v108, v108, v8
    ds_read_b128 v[24:27], v5 offset:14336
    s_waitcnt lgkmcnt(3)
    v_mfma_f32_32x32x16_bf16 v[40:55], v[32:35], v[244:247], v[40:55]
    v_lshrrev_b32 v109, 16, v110
    ds_read_b128 v[28:31], v5 offset:15360
    v_mfma_f32_32x32x16_bf16 v[56:71], v[36:39], v[244:247], v[56:71]
    v_or_b32 v109, v109, v110
    s_waitcnt lgkmcnt(2)
    v_mfma_f32_32x32x16_bf16 v[40:55], v[16:19], v[248:251], v[40:55]
    v_mfma_f32_32x32x16_bf16 v[56:71], v[20:23], v[248:251], v[56:71]
    s_waitcnt lgkmcnt(0)
    v_mfma_f32_32x32x16_bf16 v[40:55], v[24:27], v[252:255], v[40:55]
    v_mfma_f32_32x32x16_bf16 v[56:71], v[28:31], v[252:255], v[56:71]
    v_mfma_f32_32x32x16_bf16 v[40:55], v[104:107], v[124:127], v[40:55]
    v_mfma_f32_32x32x16_bf16 v[56:71], v[108:111], v[124:127], v[56:71]
    s_mul_i32 s54, s45, 88064
    s_lshl_b32 s28, s47, 10
    s_add_u32 s54, s54, s28
    s_add_u32 s54, s54, s21
    s_add_u32 s54, s54, 147456
    s_sub_u32 s30, s20, 0
    s_waitcnt vmcnt(2)
    v_subrev_u32 v13, s30, v13
    v_cmp_gt_u32 vcc, 0x400, v13
    s_nop 1
    s_cmp_eq_u64 vcc, -1
    s_cbranch_scc0 Lac29
Lab30:
    s_cmp_lg_u32 s19, 0
    s_cbranch_scc1 Lai31
Lad33:
    s_add_u32 s27, s55, s21
    buffer_load_dwordx4 v[72:75], v1, s[4:7], s27 offen sc1
    buffer_load_dwordx4 v[76:79], v1, s[4:7], s27 offen offset:1024 sc1
    s_mov_b32 s26, s54
    buffer_load_dwordx4 v[252:255], v1, s[4:7], s26 offen offset:0 sc1
    v_pk_mul_f32 v[88:89], v[40:41], v[40:41]
    v_pk_mul_f32 v[90:91], v[42:43], v[42:43]
    v_pk_mul_f32 v[92:93], v[44:45], v[44:45]
    v_pk_mul_f32 v[94:95], v[46:47], v[46:47]
    v_pk_mul_f32 v[96:97], v[48:49], v[48:49]
    v_pk_mul_f32 v[98:99], v[50:51], v[50:51]
    v_pk_mul_f32 v[100:101], v[52:53], v[52:53]
    v_pk_mul_f32 v[102:103], v[54:55], v[54:55]
    s_add_u32 s26, s54, 4096
    buffer_load_dwordx4 v[248:251], v1, s[4:7], s26 offen offset:2048 sc1
    v_pk_fma_f32 v[88:89], v[88:89], v[122:123], v[122:123] op_sel:[0,1,0] op_sel_hi:[1,1,0]
    v_pk_fma_f32 v[90:91], v[90:91], v[122:123], v[122:123] op_sel:[0,1,0] op_sel_hi:[1,1,0]
    v_pk_fma_f32 v[92:93], v[92:93], v[122:123], v[122:123] op_sel:[0,1,0] op_sel_hi:[1,1,0]
    v_pk_fma_f32 v[94:95], v[94:95], v[122:123], v[122:123] op_sel:[0,1,0] op_sel_hi:[1,1,0]
    v_pk_fma_f32 v[96:97], v[96:97], v[122:123], v[122:123] op_sel:[0,1,0] op_sel_hi:[1,1,0]
    v_pk_fma_f32 v[98:99], v[98:99], v[122:123], v[122:123] op_sel:[0,1,0] op_sel_hi:[1,1,0]
    v_pk_fma_f32 v[100:101], v[100:101], v[122:123], v[122:123] op_sel:[0,1,0] op_sel_hi:[1,1,0]
    v_pk_fma_f32 v[102:103], v[102:103], v[122:123], v[122:123] op_sel:[0,1,0] op_sel_hi:[1,1,0]
    s_add_u32 s26, s54, 12288
    buffer_load_dwordx4 v[244:247], v1, s[4:7], s26 offen offset:0 sc1
    v_pk_mul_f32 v[88:89], v[88:89], v[40:41]
    v_pk_mul_f32 v[90:91], v[90:91], v[42:43]
    v_pk_mul_f32 v[92:93], v[92:93], v[44:45]
    v_pk_mul_f32 v[94:95], v[94:95], v[46:47]
    v_pk_mul_f32 v[96:97], v[96:97], v[48:49]
    v_pk_mul_f32 v[98:99], v[98:99], v[50:51]
    v_pk_mul_f32 v[100:101], v[100:101], v[52:53]
    v_pk_mul_f32 v[102:103], v[102:103], v[54:55]
    s_add_u32 s26, s54, 16384
    buffer_load_dwordx4 v[240:243], v1, s[4:7], s26 offen offset:2048 sc1
    v_exp_f32 v88, v88
    v_exp_f32 v89, v89
    v_exp_f32 v90, v90
    v_exp_f32 v91, v91
    v_exp_f32 v92, v92
    v_exp_f32 v93, v93
    v_exp_f32 v94, v94
    v_exp_f32 v95, v95
    s_add_u32 s26, s54, 24576
    buffer_load_dwordx4 v[236:239], v1, s[4:7], s26 offen offset:0 sc1
    v_exp_f32 v96, v96
    v_exp_f32 v97, v97
    v_exp_f32 v98, v98
    v_exp_f32 v99, v99
    v_exp_f32 v100, v100
    v_exp_f32 v101, v101
    v_exp_f32 v102, v102
    v_exp_f32 v103, v103
    s_add_u32 s26, s54, 28672
    buffer_load_dwordx4 v[232:235], v1, s[4:7], s26 offen offset:2048 sc1
    s_add_u32 s20, s20, 16
    v_mov_b32 v11, 0
    v_mov_b32 v12, s20
    s_waitcnt vmcnt(8)
    s_cmp_lg_u32 s19, 0
    s_cbranch_scc1 Lsg34
    s_mov_b64 exec, 1
    buffer_store_dword v12, v11, s[4:7], s51 offen
    s_mov_b64 exec, -1
Lsb35:
    v_pk_mul_f32 v[40:41], v[40:41], v[56:57]
    v_pk_mul_f32 v[42:43], v[42:43], v[58:59]
    v_pk_mul_f32 v[44:45], v[44:45], v[60:61]
    v_pk_mul_f32 v[46:47], v[46:47], v[62:63]
    v_pk_mul_f32 v[48:49], v[48:49], v[64:65]
    v_pk_mul_f32 v[50:51], v[50:51], v[66:67]
    v_pk_mul_f32 v[52:53], v[52:53], v[68:69]
    v_pk_mul_f32 v[54:55], v[54:55], v[70:71]
    s_add_u32 s26, s54, 36864
    buffer_load_dwordx4 v[228:231], v1, s[4:7], s26 offen offset:0 sc1
    v_pk_fma_f32 v[88:89], v[88:89], v[120:121], v[120:121] op_sel:[0,1,1] op_sel_hi:[1,1,1]
    v_pk_fma_f32 v[90:91], v[90:91], v[120:121], v[120:121] op_sel:[0,1,1] op_sel_hi:[1,1,1]
    v_pk_fma_f32 v[92:93], v[92:93], v[120:121], v[120:121] op_sel:[0,1,1] op_sel_hi:[1,1,1]
    v_pk_fma_f32 v[94:95], v[94:95], v[120:121], v[120:121] op_sel:[0,1,1] op_sel_hi:[1,1,1]
    v_pk_fma_f32 v[96:97], v[96:97], v[120:121], v[120:121] op_sel:[0,1,1] op_sel_hi:[1,1,1]
    v_pk_fma_f32 v[98:99], v[98:99], v[120:121], v[120:121] op_sel:[0,1,1] op_sel_hi:[1,1,1]
    v_pk_fma_f32 v[100:101], v[100:101], v[120:121], v[120:121] op_sel:[0,1,1] op_sel_hi:[1,1,1]
    v_pk_fma_f32 v[102:103], v[102:103], v[120:121], v[120:121] op_sel:[0,1,1] op_sel_hi:[1,1,1]
    s_add_u32 s26, s54, 40960
    buffer_load_dwordx4 v[224:227], v1, s[4:7], s26 offen offset:2048 sc1
    v_rcp_f32 v88, v88
    v_rcp_f32 v89, v89
    v_rcp_f32 v90, v90
    v_rcp_f32 v91, v91
    v_rcp_f32 v92, v92
    v_rcp_f32 v93, v93
    v_rcp_f32 v94, v94
    v_rcp_f32 v95, v95
    s_add_u32 s26, s54, 49152
    buffer_load_dwordx4 v[220:223], v1, s[4:7], s26 offen offset:0 sc1
    v_rcp_f32 v96, v96
    v_rcp_f32 v97, v97
    v_rcp_f32 v98, v98
    v_rcp_f32 v99, v99
    v_rcp_f32 v100, v100
    v_rcp_f32 v101, v101
    v_rcp_f32 v102, v102
    v_rcp_f32 v103, v103
    v_pk_mul_f32 v[88:89], v[88:89], v[40:41]
    v_pk_mul_f32 v[90:91], v[90:91], v[42:43]
    v_pk_mul_f32 v[92:93], v[92:93], v[44:45]
    v_pk_mul_f32 v[94:95], v[94:95], v[46:47]
    v_pk_mul_f32 v[96:97], v[96:97], v[48:49]
    v_pk_mul_f32 v[98:99], v[98:99], v[50:51]
    v_pk_mul_f32 v[100:101], v[100:101], v[52:53]
    v_pk_mul_f32 v[102:103], v[102:103], v[54:55]
    v_cvt_pk_bf16_f32 v104, v88, v89
    v_cvt_pk_bf16_f32 v105, v90, v91
    v_cvt_pk_bf16_f32 v106, v92, v93
    v_cvt_pk_bf16_f32 v107, v94, v95
    v_cvt_pk_bf16_f32 v108, v96, v97
    v_cvt_pk_bf16_f32 v109, v98, v99
    v_cvt_pk_bf16_f32 v110, v100, v101
    v_cvt_pk_bf16_f32 v111, v102, v103
    s_mul_i32 s28, s17, 3
    s_add_u32 s28, s28, 2
    s_cmp_gt_u32 s28, 42
    s_cselect_b32 s28, 0xfe000, s28
    s_lshl_b32 s28, s28, 11
    s_add_u32 s28, s28, s56
    buffer_store_dwordx4 v[104:107], v1, s[4:7], s28 offen
    buffer_store_dwordx4 v[108:111], v1, s[4:7], s28 offen offset:1024
    s_add_u32 s26, s54, 53248
    buffer_load_dwordx4 v[216:219], v1, s[4:7], s26 offen offset:2048 sc1
    s_add_u32 s26, s54, 61440
    buffer_load_dwordx4 v[212:215], v1, s[4:7], s26 offen offset:0 sc1
    s_add_u32 s26, s54, 65536
    buffer_load_dwordx4 v[208:211], v1, s[4:7], s26 offen offset:2048 sc1
    s_add_u32 s26, s54, 73728
    buffer_load_dwordx4 v[204:207], v1, s[4:7], s26 offen offset:0 sc1
    s_add_u32 s26, s54, 77824
    buffer_load_dwordx4 v[200:203], v1, s[4:7], s26 offen offset:2048 sc1
    v_add_u32 v4, 0, v3
    v_add_u32 v5, 16384, v3
    s_barrier
    ds_read_b64_tr_b16 v[16:17], v4 offset:0
    ds_read_b64_tr_b16 v[18:19], v4 offset:512
    ds_read_b64_tr_b16 v[20:21], v4 offset:1024
    ds_read_b64_tr_b16 v[22:23], v4 offset:1536
    ds_read_b64_tr_b16 v[24:25], v4 offset:4096
    ds_read_b64_tr_b16 v[26:27], v4 offset:4608
    ds_read_b64_tr_b16 v[28:29], v4 offset:5120
    ds_read_b64_tr_b16 v[30:31], v4 offset:5632
    ds_read_b64_tr_b16 v[32:33], v4 offset:8192
    ds_read_b64_tr_b16 v[34:35], v4 offset:8704
    s_waitcnt vmcnt(16) lgkmcnt(6)
    v_mfma_f32_32x32x16_bf16 v[40:55], v[16:19], v[252:255], 0
    buffer_load_dword v13, v6, s[4:7], s44 offen sc1
    ds_read_b64_tr_b16 v[36:37], v4 offset:9216
    ds_read_b64_tr_b16 v[38:39], v4 offset:9728
    v_mfma_f32_32x32x16_bf16 v[56:71], v[20:23], v[252:255], 0
    ds_read_b64_tr_b16 v[16:17], v4 offset:12288
    ds_read_b64_tr_b16 v[18:19], v4 offset:12800
    s_waitcnt vmcnt(16) lgkmcnt(6)
    v_mfma_f32_32x32x16_bf16 v[40:55], v[24:27], v[248:251], v[40:55]
    ds_read_b64_tr_b16 v[20:21], v4 offset:13312
    ds_read_b64_tr_b16 v[22:23], v4 offset:13824
    v_mfma_f32_32x32x16_bf16 v[56:71], v[28:31], v[248:251], v[56:71]
    ds_read_b64_tr_b16 v[24:25], v5 offset:0
    ds_read_b64_tr_b16 v[26:27], v5 offset:512
    s_waitcnt vmcnt(15) lgkmcnt(6)
    v_mfma_f32_32x32x16_bf16 v[40:55], v[32:35], v[244:247], v[40:55]
    ds_read_b64_tr_b16 v[28:29], v5 offset:1024
    ds_read_b64_tr_b16 v[30:31], v5 offset:1536
    v_mfma_f32_32x32x16_bf16 v[56:71], v[36:39], v[244:247], v[56:71]
    ds_read_b64_tr_b16 v[32:33], v5 offset:4096
    ds_read_b64_tr_b16 v[34:35], v5 offset:4608
    s_waitcnt vmcnt(14) lgkmcnt(6)
    v_mfma_f32_32x32x16_bf16 v[40:55], v[16:19], v[240:243], v[40:55]
    ds_read_b64_tr_b16 v[36:37], v5 offset:5120
    ds_read_b64_tr_b16 v[38:39], v5 offset:5632
    v_mfma_f32_32x32x16_bf16 v[56:71], v[20:23], v[240:243], v[56:71]
    s_barrier
    v_add_u32 v4, 32768, v3
    s_add_u32 s26, s54, 86016
    buffer_load_dwordx4 v[196:199], v1, s[4:7], s26 offen offset:0 sc1
    ds_read_b64_tr_b16 v[16:17], v5 offset:8192
    ds_read_b64_tr_b16 v[18:19], v5 offset:8704
    s_waitcnt vmcnt(14) lgkmcnt(6)
    v_mfma_f32_32x32x16_bf16 v[40:55], v[24:27], v[236:239], v[40:55]
    ds_read_b64_tr_b16 v[20:21], v5 offset:9216
    ds_read_b64_tr_b16 v[22:23], v5 offset:9728
    v_mfma_f32_32x32x16_bf16 v[56:71], v[28:31], v[236:239], v[56:71]
    ds_read_b64_tr_b16 v[24:25], v5 offset:12288
    ds_read_b64_tr_b16 v[26:27], v5 offset:12800
    s_waitcnt vmcnt(13) lgkmcnt(6)
    v_mfma_f32_32x32x16_bf16 v[40:55], v[32:35], v[232:235], v[40:55]
    ds_read_b64_tr_b16 v[28:29], v5 offset:13312
    ds_read_b64_tr_b16 v[30:31], v5 offset:13824
    v_mfma_f32_32x32x16_bf16 v[56:71], v[36:39], v[232:235], v[56:71]
    s_sub_u32 s30, s20, 0
    s_waitcnt vmcnt(1)
    v_subrev_u32 v13, s30, v13
    v_cmp_gt_u32 vcc, 0x400, v13
    s_nop 1
    s_cmp_eq_u64 vcc, -1
    s_cbranch_scc0 Lac36
Lab37:
    s_cmp_lg_u32 s19, 0
    s_cbranch_scc1 Lai38
Lad40:
    s_mov_b32 s26, s54
    buffer_load_dwordx4 v[192:195], v1, s[4:7], s26 offen offset:2048 sc1
    s_add_u32 s26, s54, 8192
    buffer_load_dwordx4 v[188:191], v1, s[4:7], s26 offen offset:0 sc1
    ds_read_b64_tr_b16 v[32:33], v4 offset:0
    ds_read_b64_tr_b16 v[34:35], v4 offset:512
    s_waitcnt lgkmcnt(6)
    v_mfma_f32_32x32x16_bf16 v[40:55], v[16:19], v[228:231], v[40:55]
    ds_read_b64_tr_b16 v[36:37], v4 offset:1024
    ds_read_b64_tr_b16 v[38:39], v4 offset:1536
    v_mfma_f32_32x32x16_bf16 v[56:71], v[20:23], v[228:231], v[56:71]
    s_add_u32 s26, s54, 12288
    buffer_load_dwordx4 v[184:187], v1, s[4:7], s26 offen offset:2048 sc1
    ds_read_b64_tr_b16 v[16:17], v4 offset:4096
    ds_read_b64_tr_b16 v[18:19], v4 offset:4608
    s_waitcnt lgkmcnt(6)
    v_mfma_f32_32x32x16_bf16 v[40:55], v[24:27], v[224:227], v[40:55]
    s_add_u32 s20, s20, 16
    v_mov_b32 v11, 0
    v_mov_b32 v12, s20
    s_cmp_lg_u32 s19, 0
    s_cbranch_scc1 Lsg41
    s_mov_b64 exec, 1
    buffer_store_dword v12, v11, s[4:7], s51 offen
    s_mov_b64 exec, -1
Lsb42:
    ds_read_b64_tr_b16 v[20:21], v4 offset:5120
    ds_read_b64_tr_b16 v[22:23], v4 offset:5632
    v_mfma_f32_32x32x16_bf16 v[56:71], v[28:31], v[224:227], v[56:71]
    s_barrier
    v_add_u32 v5, 49152, v3
    s_add_u32 s26, s54, 20480
    buffer_load_dwordx4 v[180:183], v1, s[4:7], s26 offen offset:0 sc1
    ds_read_b64_tr_b16 v[24:25], v4 offset:8192
    ds_read_b64_tr_b16 v[26:27], v4 offset:8704
    s_waitcnt lgkmcnt(6)
    v_mfma_f32_32x32x16_bf16 v[40:55], v[32:35], v[220:223], v[40:55]
    ds_read_b64_tr_b16 v[28:29], v4 offset:9216
    ds_read_b64_tr_b16 v[30:31], v4 offset:9728
    v_mfma_f32_32x32x16_bf16 v[56:71], v[36:39], v[220:223], v[56:71]
    s_add_u32 s26, s54, 24576
    buffer_load_dwordx4 v[176:179], v1, s[4:7], s26 offen offset:2048 sc1
    ds_read_b64_tr_b16 v[32:33], v4 offset:12288
    ds_read_b64_tr_b16 v[34:35], v4 offset:12800
    s_waitcnt lgkmcnt(6)
    v_mfma_f32_32x32x16_bf16 v[40:55], v[16:19], v[216:219], v[40:55]
    ds_read_b64_tr_b16 v[36:37], v4 offset:13312
    ds_read_b64_tr_b16 v[38:39], v4 offset:13824
    v_mfma_f32_32x32x16_bf16 v[56:71], v[20:23], v[216:219], v[56:71]
    s_add_u32 s26, s54, 32768
    buffer_load_dwordx4 v[172:175], v1, s[4:7], s26 offen offset:0 sc1
    ds_read_b64_tr_b16 v[16:17], v5 offset:0
    ds_read_b64_tr_b16 v[18:19], v5 offset:512
    s_waitcnt lgkmcnt(6)
    v_mfma_f32_32x32x16_bf16 v[40:55], v[24:27], v[212:215], v[40:55]
    ds_read_b64_tr_b16 v[20:21], v5 offset:1024
    ds_read_b64_tr_b16 v[22:23], v5 offset:1536
    v_mfma_f32_32x32x16_bf16 v[56:71], v[28:31], v[212:215], v[56:71]
    s_add_u32 s26, s54, 36864
    buffer_load_dwordx4 v[168:171], v1, s[4:7], s26 offen offset:2048 sc1
    ds_read_b64_tr_b16 v[24:25], v5 offset:4096
    ds_read_b64_tr_b16 v[26:27], v5 offset:4608
    s_waitcnt lgkmcnt(6)
    v_mfma_f32_32x32x16_bf16 v[40:55], v[32:35], v[208:211], v[40:55]
    ds_read_b64_tr_b16 v[28:29], v5 offset:5120
    ds_read_b64_tr_b16 v[30:31], v5 offset:5632
    v_mfma_f32_32x32x16_bf16 v[56:71], v[36:39], v[208:211], v[56:71]
    s_barrier
    v_add_u32 v4, 65536, v3
    s_add_u32 s26, s54, 45056
    buffer_load_dwordx4 v[164:167], v1, s[4:7], s26 offen offset:0 sc1
    ds_read_b64_tr_b16 v[32:33], v5 offset:8192
    ds_read_b64_tr_b16 v[34:35], v5 offset:8704
    s_waitcnt lgkmcnt(6)
    v_mfma_f32_32x32x16_bf16 v[40:55], v[16:19], v[204:207], v[40:55]
    ds_read_b64_tr_b16 v[36:37], v5 offset:9216
    ds_read_b64_tr_b16 v[38:39], v5 offset:9728
    v_mfma_f32_32x32x16_bf16 v[56:71], v[20:23], v[204:207], v[56:71]
    s_add_u32 s26, s54, 49152
    buffer_load_dwordx4 v[160:163], v1, s[4:7], s26 offen offset:2048 sc1
    ds_read_b64_tr_b16 v[16:17], v5 offset:12288
    ds_read_b64_tr_b16 v[18:19], v5 offset:12800
    s_waitcnt lgkmcnt(6)
    v_mfma_f32_32x32x16_bf16 v[40:55], v[24:27], v[200:203], v[40:55]
    ds_read_b64_tr_b16 v[20:21], v5 offset:13312
    ds_read_b64_tr_b16 v[22:23], v5 offset:13824
    v_mfma_f32_32x32x16_bf16 v[56:71], v[28:31], v[200:203], v[56:71]
    s_add_u32 s26, s54, 57344
    buffer_load_dwordx4 v[156:159], v1, s[4:7], s26 offen offset:0 sc1
    ds_read_b64_tr_b16 v[24:25], v4 offset:0
    ds_read_b64_tr_b16 v[26:27], v4 offset:512
    s_waitcnt vmcnt(11) lgkmcnt(6)
    v_mfma_f32_32x32x16_bf16 v[40:55], v[32:35], v[196:199], v[40:55]
    buffer_load_dword v13, v6, s[4:7], s44 offen sc1
    ds_read_b64_tr_b16 v[28:29], v4 offset:1024
    ds_read_b64_tr_b16 v[30:31], v4 offset:1536
    v_mfma_f32_32x32x16_bf16 v[56:71], v[36:39], v[196:199], v[56:71]
    s_add_u32 s26, s54, 61440
    buffer_load_dwordx4 v[152:155], v1, s[4:7], s26 offen offset:2048 sc1
    ds_read_b64_tr_b16 v[32:33], v4 offset:4096
    ds_read_b64_tr_b16 v[34:35], v4 offset:4608
    s_waitcnt vmcnt(12) lgkmcnt(6)
    v_mfma_f32_32x32x16_bf16 v[40:55], v[16:19], v[192:195], v[40:55]
    ds_read_b64_tr_b16 v[36:37], v4 offset:5120
    ds_read_b64_tr_b16 v[38:39], v4 offset:5632
    v_mfma_f32_32x32x16_bf16 v[56:71], v[20:23], v[192:195], v[56:71]
    s_barrier
    v_add_u32 v5, 81920, v3
    s_add_u32 s26, s54, 69632
    buffer_load_dwordx4 v[148:151], v1, s[4:7], s26 offen offset:0 sc1
    ds_read_b64_tr_b16 v[16:17], v4 offset:8192
    ds_read_b64_tr_b16 v[18:19], v4 offset:8704
    s_waitcnt vmcnt(12) lgkmcnt(6)
    v_mfma_f32_32x32x16_bf16 v[40:55], v[24:27], v[188:191], v[40:55]
    ds_read_b64_tr_b16 v[20:21], v4 offset:9216
    ds_read_b64_tr_b16 v[22:23], v4 offset:9728
    v_mfma_f32_32x32x16_bf16 v[56:71], v[28:31], v[188:191], v[56:71]
    s_add_u32 s26, s54, 73728
    buffer_load_dwordx4 v[144:147], v1, s[4:7], s26 offen offset:2048 sc1
    ds_read_b64_tr_b16 v[24:25], v4 offset:12288
    ds_read_b64_tr_b16 v[26:27], v4 offset:12800
    s_waitcnt vmcnt(12) lgkmcnt(6)
    v_mfma_f32_32x32x16_bf16 v[40:55], v[32:35], v[184:187], v[40:55]
    ds_read_b64_tr_b16 v[28:29], v4 offset:13312
    ds_read_b64_tr_b16 v[30:31], v4 offset:13824
    v_mfma_f32_32x32x16_bf16 v[56:71], v[36:39], v[184:187], v[56:71]
    s_add_u32 s26, s54, 81920
    buffer_load_dwordx4 v[140:143], v1, s[4:7], s26 offen offset:0 sc1
    ds_read_b64_tr_b16 v[32:33], v5 offset:0
    ds_read_b64_tr_b16 v[34:35], v5 offset:512
    s_waitcnt vmcnt(11) lgkmcnt(6)
    v_mfma_f32_32x32x16_bf16 v[40:55], v[16:19], v[180:183], v[40:55]
    ds_read_b64_tr_b16 v[36:37], v5 offset:1024
    ds_read_b64_tr_b16 v[38:39], v5 offset:1536
    v_mfma_f32_32x32x16_bf16 v[56:71], v[20:23], v[180:183], v[56:71]
    ds_read_b64_tr_b16 v[16:17], v5 offset:4096
    ds_read_b64_tr_b16 v[18:19], v5 offset:4608
    s_waitcnt vmcnt(10) lgkmcnt(6)
    v_mfma_f32_32x32x16_bf16 v[40:55], v[24:27], v[176:179], v[40:55]
    ds_read_b64_tr_b16 v[20:21], v5 offset:5120
    ds_read_b64_tr_b16 v[22:23], v5 offset:5632
    v_mfma_f32_32x32x16_bf16 v[56:71], v[28:31], v[176:179], v[56:71]
    s_barrier
    v_add_u32 v4, 98304, v3
    ds_read_b64_tr_b16 v[24:25], v5 offset:8192
    ds_read_b64_tr_b16 v[26:27], v5 offset:8704
    s_waitcnt vmcnt(9) lgkmcnt(6)
    v_mfma_f32_32x32x16_bf16 v[40:55], v[32:35], v[172:175], v[40:55]
    ds_read_b64_tr_b16 v[28:29], v5 offset:9216
    ds_read_b64_tr_b16 v[30:31], v5 offset:9728
    v_mfma_f32_32x32x16_bf16 v[56:71], v[36:39], v[172:175], v[56:71]
    s_sub_u32 s30, s20, 0
    s_waitcnt vmcnt(4)
    v_subrev_u32 v13, s30, v13
    v_cmp_gt_u32 vcc, 0x400, v13
    s_nop 1
    s_cmp_eq_u64 vcc, -1
    s_cbranch_scc0 Lac43
Lab44:
    s_cmp_lg_u32 s19, 0
    s_cbranch_scc1 Lai45
Lad47:
    s_add_u32 s26, s54, 4096
    buffer_load_dwordx4 v[136:139], v1, s[4:7], s26 offen offset:0 sc1
    s_add_u32 s26, s54, 8192
    buffer_load_dwordx4 v[132:135], v1, s[4:7], s26 offen offset:2048 sc1
    ds_read_b64_tr_b16 v[32:33], v5 offset:12288
    ds_read_b64_tr_b16 v[34:35], v5 offset:12800
    s_waitcnt lgkmcnt(6)
    v_mfma_f32_32x32x16_bf16 v[40:55], v[16:19], v[168:171], v[40:55]
    ds_read_b64_tr_b16 v[36:37], v5 offset:13312
    ds_read_b64_tr_b16 v[38:39], v5 offset:13824
    v_mfma_f32_32x32x16_bf16 v[56:71], v[20:23], v[168:171], v[56:71]
    s_add_u32 s26, s54, 16384
    buffer_load_dwordx4 v[128:131], v1, s[4:7], s26 offen offset:0 sc1
    s_add_u32 s26, s54, 20480
    buffer_load_dwordx4 v[124:127], v1, s[4:7], s26 offen offset:2048 sc1
    ds_read_b64_tr_b16 v[16:17], v4 offset:0
    ds_read_b64_tr_b16 v[18:19], v4 offset:512
    s_waitcnt lgkmcnt(6)
    v_mfma_f32_32x32x16_bf16 v[40:55], v[24:27], v[164:167], v[40:55]
    ds_read_b64_tr_b16 v[20:21], v4 offset:1024
    ds_read_b64_tr_b16 v[22:23], v4 offset:1536
    v_mfma_f32_32x32x16_bf16 v[56:71], v[28:31], v[164:167], v[56:71]
    s_add_u32 s26, s54, 28672
    buffer_load_dwordx4 v[120:123], v1, s[4:7], s26 offen offset:0 sc1
    ds_read_b64_tr_b16 v[24:25], v4 offset:4096
    ds_read_b64_tr_b16 v[26:27], v4 offset:4608
    s_waitcnt lgkmcnt(6)
    v_mfma_f32_32x32x16_bf16 v[40:55], v[32:35], v[160:163], v[40:55]
    ds_read_b64_tr_b16 v[28:29], v4 offset:5120
    ds_read_b64_tr_b16 v[30:31], v4 offset:5632
    v_mfma_f32_32x32x16_bf16 v[56:71], v[36:39], v[160:163], v[56:71]
    s_barrier
    v_add_u32 v5, 114688, v3
    s_add_u32 s26, s54, 32768
    buffer_load_dwordx4 v[116:119], v1, s[4:7], s26 offen offset:2048 sc1
    ds_read_b64_tr_b16 v[32:33], v4 offset:8192
    ds_read_b64_tr_b16 v[34:35], v4 offset:8704
    s_waitcnt lgkmcnt(6)
    v_mfma_f32_32x32x16_bf16 v[40:55], v[16:19], v[156:159], v[40:55]
    ds_read_b64_tr_b16 v[36:37], v4 offset:9216
    ds_read_b64_tr_b16 v[38:39], v4 offset:9728
    v_mfma_f32_32x32x16_bf16 v[56:71], v[20:23], v[156:159], v[56:71]
    s_add_u32 s26, s54, 40960
    buffer_load_dwordx4 v[112:115], v1, s[4:7], s26 offen offset:0 sc1
    ds_read_b64_tr_b16 v[16:17], v4 offset:12288
    ds_read_b64_tr_b16 v[18:19], v4 offset:12800
    s_waitcnt vmcnt(10) lgkmcnt(6)
    v_mfma_f32_32x32x16_bf16 v[40:55], v[24:27], v[152:155], v[40:55]
    ds_read_b64_tr_b16 v[20:21], v4 offset:13312
    ds_read_b64_tr_b16 v[22:23], v4 offset:13824
    v_mfma_f32_32x32x16_bf16 v[56:71], v[28:31], v[152:155], v[56:71]
    s_add_u32 s26, s54, 45056
    buffer_load_dwordx4 v[108:111], v1, s[4:7], s26 offen offset:2048 sc1
    ds_read_b64_tr_b16 v[24:25], v5 offset:0
    ds_read_b64_tr_b16 v[26:27], v5 offset:512
    s_waitcnt vmcnt(10) lgkmcnt(6)
    v_mfma_f32_32x32x16_bf16 v[40:55], v[32:35], v[148:151], v[40:55]
    ds_read_b64_tr_b16 v[28:29], v5 offset:1024
    ds_read_b64_tr_b16 v[30:31], v5 offset:1536
    v_mfma_f32_32x32x16_bf16 v[56:71], v[36:39], v[148:151], v[56:71]
    s_add_u32 s26, s54, 53248
    buffer_load_dwordx4 v[104:107], v1, s[4:7], s26 offen offset:0 sc1
    ds_read_b64_tr_b16 v[32:33], v5 offset:4096
    ds_read_b64_tr_b16 v[34:35], v5 offset:4608
    s_waitcnt vmcnt(10) lgkmcnt(6)
    v_mfma_f32_32x32x16_bf16 v[40:55], v[16:19], v[144:147], v[40:55]
    ds_read_b64_tr_b16 v[36:37], v5 offset:5120
    ds_read_b64_tr_b16 v[38:39], v5 offset:5632
    v_mfma_f32_32x32x16_bf16 v[56:71], v[20:23], v[144:147], v[56:71]
    s_barrier
    v_add_u32 v4, 131072, v3
    s_add_u32 s26, s54, 57344
    buffer_load_dwordx4 v[100:103], v1, s[4:7], s26 offen offset:2048 sc1
    ds_read_b64_tr_b16 v[16:17], v5 offset:8192
    ds_read_b64_tr_b16 v[18:19], v5 offset:8704
    s_waitcnt vmcnt(10) lgkmcnt(6)
    v_mfma_f32_32x32x16_bf16 v[40:55], v[24:27], v[140:143], v[40:55]
    ds_read_b64_tr_b16 v[20:21], v5 offset:9216
    ds_read_b64_tr_b16 v[22:23], v5 offset:9728
    v_mfma_f32_32x32x16_bf16 v[56:71], v[28:31], v[140:143], v[56:71]
    s_add_u32 s26, s54, 65536
    buffer_load_dwordx4 v[96:99], v1, s[4:7], s26 offen offset:0 sc1
    ds_read_b64_tr_b16 v[24:25], v5 offset:12288
    ds_read_b64_tr_b16 v[26:27], v5 offset:12800
    s_waitcnt vmcnt(10) lgkmcnt(6)
    v_mfma_f32_32x32x16_bf16 v[40:55], v[32:35], v[136:139], v[40:55]
    ds_read_b64_tr_b16 v[28:29], v5 offset:13312
    ds_read_b64_tr_b16 v[30:31], v5 offset:13824
    v_mfma_f32_32x32x16_bf16 v[56:71], v[36:39], v[136:139], v[56:71]
    s_add_u32 s26, s54, 69632
    buffer_load_dwordx4 v[92:95], v1, s[4:7], s26 offen offset:2048 sc1
    ds_read_b64_tr_b16 v[32:33], v4 offset:0
    ds_read_b64_tr_b16 v[34:35], v4 offset:512
    s_waitcnt vmcnt(10) lgkmcnt(6)
    v_mfma_f32_32x32x16_bf16 v[40:55], v[16:19], v[132:135], v[40:55]
    ds_read_b64_tr_b16 v[36:37], v4 offset:1024
    ds_read_b64_tr_b16 v[38:39], v4 offset:1536
    v_mfma_f32_32x32x16_bf16 v[56:71], v[20:23], v[132:135], v[56:71]
    s_add_u32 s26, s54, 77824
    buffer_load_dwordx4 v[88:91], v1, s[4:7], s26 offen offset:0 sc1
    ds_read_b64_tr_b16 v[16:17], v4 offset:4096
    ds_read_b64_tr_b16 v[18:19], v4 offset:4608
    s_waitcnt vmcnt(10) lgkmcnt(6)
    v_mfma_f32_32x32x16_bf16 v[40:55], v[24:27], v[128:131], v[40:55]
    ds_read_b64_tr_b16 v[20:21], v4 offset:5120
    ds_read_b64_tr_b16 v[22:23], v4 offset:5632
    v_mfma_f32_32x32x16_bf16 v[56:71], v[28:31], v[128:131], v[56:71]
    s_barrier
    v_add_u32 v5, 0, v3
    s_add_u32 s26, s54, 81920
    buffer_load_dwordx4 v[84:87], v1, s[4:7], s26 offen offset:2048 sc1
    ds_read_b64_tr_b16 v[24:25], v4 offset:8192
    ds_read_b64_tr_b16 v[26:27], v4 offset:8704
    s_waitcnt vmcnt(10) lgkmcnt(6)
    v_mfma_f32_32x32x16_bf16 v[40:55], v[32:35], v[124:127], v[40:55]
    ds_read_b64_tr_b16 v[28:29], v4 offset:9216
    ds_read_b64_tr_b16 v[30:31], v4 offset:9728
    v_mfma_f32_32x32x16_bf16 v[56:71], v[36:39], v[124:127], v[56:71]
    ds_read_b64_tr_b16 v[32:33], v4 offset:12288
    ds_read_b64_tr_b16 v[34:35], v4 offset:12800
    s_waitcnt vmcnt(9) lgkmcnt(6)
    v_mfma_f32_32x32x16_bf16 v[40:55], v[16:19], v[120:123], v[40:55]
    ds_read_b64_tr_b16 v[36:37], v4 offset:13312
    ds_read_b64_tr_b16 v[38:39], v4 offset:13824
    v_mfma_f32_32x32x16_bf16 v[56:71], v[20:23], v[120:123], v[56:71]
    ds_read_b64_tr_b16 v[16:17], v5 offset:0
    ds_read_b64_tr_b16 v[18:19], v5 offset:512
    s_waitcnt vmcnt(8) lgkmcnt(6)
    v_mfma_f32_32x32x16_bf16 v[40:55], v[24:27], v[116:119], v[40:55]
    ds_read_b64_tr_b16 v[20:21], v5 offset:1024
    ds_read_b64_tr_b16 v[22:23], v5 offset:1536
    v_mfma_f32_32x32x16_bf16 v[56:71], v[28:31], v[116:119], v[56:71]
    ds_read_b64_tr_b16 v[24:25], v5 offset:4096
    ds_read_b64_tr_b16 v[26:27], v5 offset:4608
    s_waitcnt vmcnt(7) lgkmcnt(6)
    v_mfma_f32_32x32x16_bf16 v[40:55], v[32:35], v[112:115], v[40:55]
    ds_read_b64_tr_b16 v[28:29], v5 offset:5120
    ds_read_b64_tr_b16 v[30:31], v5 offset:5632
    v_mfma_f32_32x32x16_bf16 v[56:71], v[36:39], v[112:115], v[56:71]
    s_barrier
    v_add_u32 v4, 16384, v3
    ds_read_b64_tr_b16 v[32:33], v5 offset:8192
    ds_read_b64_tr_b16 v[34:35], v5 offset:8704
    s_waitcnt vmcnt(6) lgkmcnt(6)
    v_mfma_f32_32x32x16_bf16 v[40:55], v[16:19], v[108:111], v[40:55]
    ds_read_b64_tr_b16 v[36:37], v5 offset:9216
    ds_read_b64_tr_b16 v[38:39], v5 offset:9728
    v_mfma_f32_32x32x16_bf16 v[56:71], v[20:23], v[108:111], v[56:71]
    ds_read_b64_tr_b16 v[16:17], v5 offset:12288
    ds_read_b64_tr_b16 v[18:19], v5 offset:12800
    s_waitcnt vmcnt(5) lgkmcnt(6)
    v_mfma_f32_32x32x16_bf16 v[40:55], v[24:27], v[104:107], v[40:55]
    ds_read_b64_tr_b16 v[20:21], v5 offset:13312
    ds_read_b64_tr_b16 v[22:23], v5 offset:13824
    v_mfma_f32_32x32x16_bf16 v[56:71], v[28:31], v[104:107], v[56:71]
    ds_read_b64_tr_b16 v[24:25], v4 offset:0
    ds_read_b64_tr_b16 v[26:27], v4 offset:512
    s_waitcnt vmcnt(4) lgkmcnt(6)
    v_mfma_f32_32x32x16_bf16 v[40:55], v[32:35], v[100:103], v[40:55]
    ds_read_b64_tr_b16 v[28:29], v4 offset:1024
    ds_read_b64_tr_b16 v[30:31], v4 offset:1536
    v_mfma_f32_32x32x16_bf16 v[56:71], v[36:39], v[100:103], v[56:71]
    ds_read_b64_tr_b16 v[32:33], v4 offset:4096
    ds_read_b64_tr_b16 v[34:35], v4 offset:4608
    s_waitcnt vmcnt(3) lgkmcnt(6)
    v_mfma_f32_32x32x16_bf16 v[40:55], v[16:19], v[96:99], v[40:55]
    ds_read_b64_tr_b16 v[36:37], v4 offset:5120
    ds_read_b64_tr_b16 v[38:39], v4 offset:5632
    v_mfma_f32_32x32x16_bf16 v[56:71], v[20:23], v[96:99], v[56:71]
    s_barrier
    ds_read_b64_tr_b16 v[16:17], v4 offset:8192
    ds_read_b64_tr_b16 v[18:19], v4 offset:8704
    s_waitcnt vmcnt(2) lgkmcnt(6)
    v_mfma_f32_32x32x16_bf16 v[40:55], v[24:27], v[92:95], v[40:55]
    ds_read_b64_tr_b16 v[20:21], v4 offset:9216
    ds_read_b64_tr_b16 v[22:23], v4 offset:9728
    v_mfma_f32_32x32x16_bf16 v[56:71], v[28:31], v[92:95], v[56:71]
    s_waitcnt vmcnt(1) lgkmcnt(4)
    v_mfma_f32_32x32x16_bf16 v[40:55], v[32:35], v[88:91], v[40:55]
    v_mfma_f32_32x32x16_bf16 v[56:71], v[36:39], v[88:91], v[56:71]
    s_waitcnt vmcnt(0) lgkmcnt(0)
    v_mfma_f32_32x32x16_bf16 v[40:55], v[16:19], v[84:87], v[40:55]
    v_mfma_f32_32x32x16_bf16 v[56:71], v[20:23], v[84:87], v[56:71]
    s_lshl_b32 s24, s18, 12
    s_add_u32 s24, s24, 131072
    v_add_u32 v8, s24, v1
    s_xor_b32 s25, s18, 2
    s_lshl_b32 s25, s25, 12
    s_add_u32 s25, s25, 131072
    v_add_u32 v9, s25, v1
    s_nop 4
    ds_write_b128 v8, v[56:59] offset:0
    ds_write_b128 v8, v[60:63] offset:1024
    ds_write_b128 v8, v[64:67] offset:2048
    ds_write_b128 v8, v[68:71] offset:3072
    v_lshlrev_b32 v104, 16, v72
    v_and_b32 v105, s41, v72
    v_lshlrev_b32 v106, 16, v73
    v_and_b32 v107, s41, v73
    v_lshlrev_b32 v108, 16, v74
    v_and_b32 v109, s41, v74
    v_lshlrev_b32 v110, 16, v75
    v_and_b32 v111, s41, v75
    v_lshlrev_b32 v112, 16, v76
    v_and_b32 v113, s41, v76
    v_lshlrev_b32 v114, 16, v77
    v_and_b32 v115, s41, v77
    v_lshlrev_b32 v116, 16, v78
    v_and_b32 v117, s41, v78
    v_lshlrev_b32 v118, 16, v79
    v_and_b32 v119, s41, v79
    v_pk_add_f32 v[40:41], v[40:41], v[104:105]
    v_pk_add_f32 v[42:43], v[42:43], v[106:107]
    v_pk_add_f32 v[44:45], v[44:45], v[108:109]
    v_pk_add_f32 v[46:47], v[46:47], v[110:111]
    v_pk_add_f32 v[48:49], v[48:49], v[112:113]
    v_pk_add_f32 v[50:51], v[50:51], v[114:115]
    v_pk_add_f32 v[52:53], v[52:53], v[116:117]
    v_pk_add_f32 v[54:55], v[54:55], v[118:119]
    s_waitcnt lgkmcnt(0)
    s_barrier
    ds_read_b128 v[56:59], v9 offset:0
    ds_read_b128 v[60:63], v9 offset:1024
    ds_read_b128 v[64:67], v9 offset:2048
    ds_read_b128 v[68:71], v9 offset:3072
    s_add_u32 s24, s55, s50
    s_waitcnt lgkmcnt(3)
    v_pk_add_f32 v[40:41], v[40:41], v[56:57]
    v_pk_add_f32 v[42:43], v[42:43], v[58:59]
    s_waitcnt lgkmcnt(2)
    v_pk_add_f32 v[44:45], v[44:45], v[60:61]
    v_pk_add_f32 v[46:47], v[46:47], v[62:63]
    s_waitcnt lgkmcnt(1)
    v_pk_add_f32 v[48:49], v[48:49], v[64:65]
    v_pk_add_f32 v[50:51], v[50:51], v[66:67]
    s_waitcnt lgkmcnt(0)
    v_pk_add_f32 v[52:53], v[52:53], v[68:69]
    v_pk_add_f32 v[54:55], v[54:55], v[70:71]
    v_cvt_pk_bf16_f32 v72, v40, v41
    v_cvt_pk_bf16_f32 v73, v42, v43
    v_cvt_pk_bf16_f32 v74, v44, v45
    v_cvt_pk_bf16_f32 v75, v46, v47
    v_cvt_pk_bf16_f32 v76, v48, v49
    v_cvt_pk_bf16_f32 v77, v50, v51
    v_cvt_pk_bf16_f32 v78, v52, v53
    v_cvt_pk_bf16_f32 v79, v54, v55
    s_cmp_eq_u32 s23, 1
    s_cbranch_scc1 Lf48
    buffer_store_dwordx4 v[72:75], v1, s[4:7], s24 offen
    buffer_store_dwordx4 v[76:79], v1, s[4:7], s24 offen offset:1024
    v_mov_b32 v10, 0
    v_mov_b32 v11, 0
    v_mov_b32 v12, s43
    s_lshl_b32 s24, s45, 12
    s_lshl_b32 s25, s46, 9
    s_add_u32 s24, s24, s25
    s_lshl_b32 s25, s47, 8
    s_add_u32 s24, s24, s25
    s_add_u32 s24, s24, s50
    s_add_u32 s24, s24, 131072
    v_dot2c_f32_bf16 v10, v72, v12
    v_dot2c_f32_bf16 v11, v72, v72
    v_dot2c_f32_bf16 v10, v73, v12
    v_dot2c_f32_bf16 v11, v73, v73
    v_dot2c_f32_bf16 v10, v74, v12
    v_dot2c_f32_bf16 v11, v74, v74
    v_dot2c_f32_bf16 v10, v75, v12
    v_dot2c_f32_bf16 v11, v75, v75
    v_dot2c_f32_bf16 v10, v76, v12
    v_dot2c_f32_bf16 v11, v76, v76
    v_dot2c_f32_bf16 v10, v77, v12
    v_dot2c_f32_bf16 v11, v77, v77
    v_dot2c_f32_bf16 v10, v78, v12
    v_dot2c_f32_bf16 v11, v78, v78
    v_dot2c_f32_bf16 v10, v79, v12
    v_dot2c_f32_bf16 v11, v79, v79
    v_and_b32 v8, 31, v7
    v_lshlrev_b32 v8, 3, v8
    v_mov_b32 v104, v10
    v_mov_b32 v105, v11
    s_nop 0
    v_permlane32_swap_b32 v10, v104
    v_permlane32_swap_b32 v11, v105
    v_add_f32 v10, v10, v104
    v_add_f32 v11, v11, v105
    s_mov_b32 exec_hi, 0
    buffer_store_dwordx2 v[10:11], v8, s[4:7], s24 offen
    s_mov_b64 exec, -1
    s_add_u32 s20, s20, 16
    v_mov_b32 v11, 0
    v_mov_b32 v12, s20
    s_waitcnt vmcnt(0)
    s_cmp_lg_u32 s19, 0
    s_cbranch_scc1 Lsg50
    s_mov_b64 exec, 1
    buffer_store_dword v12, v11, s[4:7], s51 offen
    s_mov_b64 exec, -1
Lsb51:
    s_mov_b32 s48, 0
Lp54:
    buffer_load_dword v13, v6, s[4:7], s44 offen sc1
    s_waitcnt vmcnt(0)
    v_subrev_u32 v13, s20, v13
    v_cmp_gt_u32 vcc, 0x400, v13
    s_nop 1
    s_cmp_eq_u64 vcc, -1
    s_cbranch_scc1 Lpd55
    s_add_u32 s48, s48, 1
    s_cmp_lt_u32 s48, 400000
    s_cbranch_scc1 Lp54
    s_mov_b32 s49, 1
Lpd55:
    s_cmp_lg_u32 s19, 0
    s_cbranch_scc1 Lwi52
Lwb53:
    s_branch Lf49
Lf48:
    s_nop 1
    v_permlane32_swap_b32 v72, v74
    v_permlane32_swap_b32 v73, v75
    v_permlane32_swap_b32 v76, v78
    v_permlane32_swap_b32 v77, v79
    v_and_b32 v8, 31, v7
    v_lshlrev_b32 v8, 10, v8
    v_lshrrev_b32 v9, 5, v7
    v_lshl_add_u32 v8, v9, 4, v8
    s_lshl_b32 s24, s16, 17
    s_lshl_b32 s25, s45, 15
    s_add_u32 s24, s24, s25
    s_lshl_b32 s25, s46, 7
    s_add_u32 s24, s24, s25
    s_lshl_b32 s25, s47, 6
    s_add_u32 s24, s24, s25
    buffer_store_dwordx4 v[72:75], v8, s[8:11], s24 offen
    buffer_store_dwordx4 v[76:79], v8, s[8:11], s24 offen offset:32
Lf49:
    s_mov_b32 s21, s50
    s_add_u32 s23, s23, 1
    s_cmp_lt_u32 s23, 2
    s_cbranch_scc1 L_layer
    s_or_b32 s24, s17, s18
    s_cmp_lg_u32 s24, 0
    s_cbranch_scc1 Ltag56
    s_add_u32 s24, s57, 1
    s_add_u32 s25, s44, 640
    v_mov_b32 v8, 0
    v_mov_b32 v9, s24
    s_mov_b64 exec, 1
    buffer_store_dword v9, v8, s[4:7], s25 offen sc0 sc1
    s_mov_b64 exec, -1
Ltag56:
    s_branch L_end
L_helper:
    s_sub_u32 s18, s3, 4
    s_mul_i32 s95, s16, 524288
    s_add_u32 s40, s95, 500352
    s_load_dword s62, s[82:83], s40
    s_mov_b32 s8, s66
    s_and_b32 s9, s67, 0xffff
    s_mov_b32 s10, 1572864
    s_mov_b32 s11, 0x00020000
    s_lshl_b32 s19, s18, 12
    s_lshl_b32 s38, s17, 6
    s_mul_i32 s32, s18, 98304
    s_add_u32 s32, s32, s38
    s_mul_i32 s33, s18, 196608
    s_add_u32 s33, s33, s38
    v_lshrrev_b32 v16, 2, v7
    v_and_b32 v17, 3, v7
    v_lshlrev_b32 v17, 4, v17
    v_mul_u32_u24 v8, 3072, v16
    v_add_u32 v8, v8, v17
    s_cmp_lg_u32 s18, 2
    s_cbranch_scc1 Lcp57
    s_getpc_b64 s[42:43]
L_pc:
    s_sub_u32 s42, s42, L_pc-interleave_layers__linear_attn_block__glu_gated_geglu__prompt_kernel
    s_subb_u32 s43, s43, 0
    s_and_b32 s40, s16, 1
    s_lshl_b32 s40, s40, 4
    s_add_u32 s40, s40, s17
    s_mul_i32 s40, s40, 1280
    v_lshlrev_b32 v63, 7, v7
    v_add_u32 v63, s40, v63
    v_min_u32 v63, L_end-interleave_layers__linear_attn_block__glu_gated_geglu__prompt_kernel, v63
    s_mov_b64 exec, 0x3ff
    global_load_dword v59, v63, s[42:43]
    s_mov_b64 exec, -1
Lcp57:
    s_lshl_b32 s40, s2, 2
    s_add_u32 s40, s40, s18
    s_mul_i32 s40, s40, 1536
    v_lshlrev_b32 v63, 7, v7
    s_mov_b64 exec, 0xfff
    buffer_load_dword v59, v63, s[8:11], s40 offen
    s_mov_b64 exec, -1
    s_mov_b32 s12, s68
    s_and_b32 s13, s69, 0xffff
    s_mov_b32 s14, 524288
    s_mov_b32 s15, 0x00020000
    s_mov_b32 s20, s72
    s_and_b32 s21, s73, 0xffff
    s_mov_b32 s22, 1409024
    s_mov_b32 s23, 0x00020000
    s_mov_b32 s24, s74
    s_and_b32 s25, s75, 0xffff
    s_mov_b32 s26, 1409024
    s_mov_b32 s27, 0x00020000
    s_mov_b32 s28, s76
    s_and_b32 s29, s77, 0xffff
    s_mov_b32 s30, 1409024
    s_mov_b32 s31, 0x00020000
    s_and_b32 s38, s17, 7
    s_lshl_b32 s39, s38, 7
    s_lshl_b32 s34, s18, 14
    s_add_u32 s34, s34, s39
    s_mul_i32 s38, s17, 3
    s_add_u32 s38, s38, 0
    s_min_u32 s38, s38, 42
    s_lshl_b32 s38, s38, 6
    s_mul_i32 s35, s18, 88064
    s_add_u32 s35, s35, s38
    s_mul_i32 s38, s17, 3
    s_add_u32 s38, s38, 0
    s_cmp_gt_u32 s38, 42
    s_cselect_b32 s35, 0x7f000000, s35
    s_mul_i32 s38, s17, 3
    s_add_u32 s38, s38, 1
    s_min_u32 s38, s38, 42
    s_lshl_b32 s38, s38, 6
    s_mul_i32 s36, s18, 88064
    s_add_u32 s36, s36, s38
    s_mul_i32 s38, s17, 3
    s_add_u32 s38, s38, 1
    s_cmp_gt_u32 s38, 42
    s_cselect_b32 s36, 0x7f000000, s36
    s_mul_i32 s38, s17, 3
    s_add_u32 s38, s38, 2
    s_min_u32 s38, s38, 42
    s_lshl_b32 s38, s38, 6
    s_mul_i32 s37, s18, 88064
    s_add_u32 s37, s37, s38
    s_mul_i32 s38, s17, 3
    s_add_u32 s38, s38, 2
    s_cmp_gt_u32 s38, 42
    s_cselect_b32 s37, 0x7f000000, s37
    s_add_u32 s38, s18, 0
    s_sub_u32 s40, s38, 0
    s_mul_i32 s40, s40, 3
    s_lshl_b32 s40, s40, 15
    s_add_u32 s84, s40, s39
    s_add_u32 s38, s18, 4
    s_sub_u32 s40, s38, 0
    s_mul_i32 s40, s40, 3
    s_lshl_b32 s40, s40, 15
    s_add_u32 s85, s40, s39
    s_add_u32 s38, s18, 8
    s_sub_u32 s40, s38, 0
    s_mul_i32 s40, s40, 3
    s_lshl_b32 s40, s40, 15
    s_add_u32 s86, s40, s39
    s_add_u32 s38, s18, 12
    s_sub_u32 s40, s38, 0
    s_mul_i32 s40, s40, 3
    s_sub_u32 s41, s38, 15
    s_mul_i32 s41, s41, 3
    s_add_u32 s41, s41, 1
    s_cmp_lt_u32 s38, 15
    s_cselect_b32 s40, s40, s41
    s_lshl_b32 s40, s40, 15
    s_add_u32 s87, s40, s39
    s_add_u32 s38, s18, 16
    s_sub_u32 s40, s38, 15
    s_mul_i32 s40, s40, 3
    s_add_u32 s40, s40, 1
    s_lshl_b32 s40, s40, 15
    s_add_u32 s88, s40, s39
    s_add_u32 s38, s18, 20
    s_sub_u32 s40, s38, 15
    s_mul_i32 s40, s40, 3
    s_add_u32 s40, s40, 1
    s_lshl_b32 s40, s40, 15
    s_add_u32 s89, s40, s39
    s_add_u32 s38, s18, 24
    s_sub_u32 s40, s38, 15
    s_mul_i32 s40, s40, 3
    s_add_u32 s40, s40, 1
    s_lshl_b32 s40, s40, 15
    s_add_u32 s90, s40, s39
    s_add_u32 s38, s18, 28
    s_sub_u32 s40, s38, 15
    s_mul_i32 s40, s40, 3
    s_add_u32 s40, s40, 1
    s_sub_u32 s41, s38, 29
    s_mul_i32 s41, s41, 3
    s_add_u32 s41, s41, 2
    s_cmp_lt_u32 s38, 29
    s_cselect_b32 s40, s40, s41
    s_lshl_b32 s40, s40, 15
    s_add_u32 s91, s40, s39
    s_add_u32 s38, s18, 32
    s_sub_u32 s40, s38, 29
    s_mul_i32 s40, s40, 3
    s_add_u32 s40, s40, 2
    s_lshl_b32 s40, s40, 15
    s_add_u32 s92, s40, s39
    s_add_u32 s38, s18, 36
    s_sub_u32 s40, s38, 29
    s_mul_i32 s40, s40, 3
    s_add_u32 s40, s40, 2
    s_lshl_b32 s40, s40, 15
    s_add_u32 s93, s40, s39
    s_add_u32 s38, s18, 40
    s_sub_u32 s40, s38, 29
    s_mul_i32 s40, s40, 3
    s_add_u32 s40, s40, 2
    s_lshl_b32 s40, s40, 15
    s_add_u32 s94, s40, s39
    v_lshl_add_u32 v9, v16, 10, v17
    v_mul_u32_u24 v10, 2752, v16
    v_add_u32 v10, v10, v17
    v_add_u32 v11, s19, v2
    v_mov_b32 v12, 0
    v_mov_b32 v13, 0
    v_mov_b32 v14, 0
    v_mov_b32 v15, 0
    s_mov_b32 s58, 0xffff0000
    s_waitcnt vmcnt(0)
    s_add_u32 m0, s19, 32768
    s_add_u32 s38, s32, 1024
    buffer_load_dwordx4 v8, s[8:11], s38 offen lds
    s_add_u32 m0, s19, 33792
    s_add_u32 s38, s32, 2048
    buffer_load_dwordx4 v8, s[8:11], s38 offen lds
    s_add_u32 m0, s19, 34816
    s_add_u32 s38, s32, 50176
    buffer_load_dwordx4 v8, s[8:11], s38 offen lds
    s_add_u32 m0, s19, 35840
    s_add_u32 s38, s32, 51200
    buffer_load_dwordx4 v8, s[8:11], s38 offen lds
    s_add_u32 m0, s19, 49152
    s_add_u32 s38, s32, 394240
    buffer_load_dwordx4 v8, s[8:11], s38 offen lds
    s_add_u32 m0, s19, 50176
    s_add_u32 s38, s32, 395264
    buffer_load_dwordx4 v8, s[8:11], s38 offen lds
    s_add_u32 m0, s19, 51200
    s_add_u32 s38, s32, 443392
    buffer_load_dwordx4 v8, s[8:11], s38 offen lds
    s_add_u32 m0, s19, 52224
    s_add_u32 s38, s32, 444416
    buffer_load_dwordx4 v8, s[8:11], s38 offen lds
    s_cmp_lg_u32 s18, 2
    s_cbranch_scc1 Lz58
    s_cmp_lg_u32 s17, s16
    s_cbranch_scc1 Lz58
    v_mov_b32 v40, 0
    v_mov_b32 v41, 0
    v_mov_b32 v42, 0
    v_mov_b32 v43, 0
    s_lshl_b32 s40, s17, 12
    s_add_u32 s40, s40, 67108864
    buffer_store_dwordx4 v[40:43], v1, s[4:7], s40 offen offset:0 sc0 sc1
    buffer_store_dwordx4 v[40:43], v1, s[4:7], s40 offen offset:1024 sc0 sc1
    buffer_store_dwordx4 v[40:43], v1, s[4:7], s40 offen offset:2048 sc0 sc1
    s_add_u32 s40, s40, 0x10000
    buffer_store_dwordx4 v[40:43], v1, s[4:7], s40 offen offset:0 sc0 sc1
    buffer_store_dwordx4 v[40:43], v1, s[4:7], s40 offen offset:1024 sc0 sc1
    buffer_store_dwordx4 v[40:43], v1, s[4:7], s40 offen offset:2048 sc0 sc1
Lz58:
    s_mul_i32 s40, s16, 524288
    s_lshl_b32 s41, s17, 2
    s_add_u32 s41, s41, s18
    s_mul_i32 s41, s41, 2304
    s_add_u32 s40, s40, s41
    s_add_u32 s40, s40, 0
    v_lshlrev_b32 v63, 7, v7
    s_mov_b32 exec_lo, 0x3ffff
    s_mov_b32 exec_hi, 0x0
    buffer_load_dword v59, v63, s[4:7], s40 offen
    s_mov_b64 exec, -1
    s_waitcnt lgkmcnt(0)
    s_mul_i32 s62, s62, 0x9e3779b1
    s_add_u32 s62, s62, 0x6a09e667
    v_add_u32 v0, s19, v1
    v_lshlrev_b32 v63, 7, v7
    s_and_b32 s59, s16, 1
    s_lshl_b32 s59, s59, 4
    s_add_u32 s59, s59, s17
    s_barrier
    s_cmp_lg_u32 s18, 3
    s_cbranch_scc1 Lb59
    s_getreg_b32 s40, hwreg(HW_REG_XCC_ID, 0, 4)
    s_add_u32 s40, s40, s62
    s_add_u32 s40, s40, 16
    s_lshl_b32 s41, s17, 2
    s_add_u32 s41, s41, s95
    s_add_u32 s41, s41, 500096
    v_mov_b32 v16, 0
    v_mov_b32 v17, s40
    s_mov_b64 exec, 1
    buffer_store_dword v17, v16, s[4:7], s41 offen sc0 sc1
    s_mov_b64 exec, -1
Lb59:
    s_add_u32 m0, s19, 65536
    s_add_u32 s38, s32, 787456
    buffer_load_dwordx4 v8, s[8:11], s38 offen lds
    s_add_u32 m0, s19, 66560
    s_add_u32 s38, s32, 788480
    buffer_load_dwordx4 v8, s[8:11], s38 offen lds
    s_add_u32 m0, s19, 67584
    s_add_u32 s38, s32, 836608
    buffer_load_dwordx4 v8, s[8:11], s38 offen lds
    s_add_u32 m0, s19, 68608
    s_add_u32 s38, s32, 837632
    buffer_load_dwordx4 v8, s[8:11], s38 offen lds
    s_add_u32 m0, s19, 81920
    s_add_u32 s38, s32, 1180672
    buffer_load_dwordx4 v8, s[8:11], s38 offen lds
    s_add_u32 m0, s19, 82944
    s_add_u32 s38, s32, 1181696
    buffer_load_dwordx4 v8, s[8:11], s38 offen lds
    s_add_u32 m0, s19, 83968
    s_add_u32 s38, s32, 1229824
    buffer_load_dwordx4 v8, s[8:11], s38 offen lds
    s_add_u32 m0, s19, 84992
    s_add_u32 s38, s32, 1230848
    buffer_load_dwordx4 v8, s[8:11], s38 offen lds
    s_waitcnt vmcnt(12)
    v_add_u32 v32, 32768, v11
    ds_read_b64_tr_b16 v[16:17], v32 offset:0
    ds_read_b64_tr_b16 v[18:19], v32 offset:512
    ds_read_b64_tr_b16 v[20:21], v32 offset:1024
    ds_read_b64_tr_b16 v[22:23], v32 offset:1536
    ds_read_b64_tr_b16 v[24:25], v32 offset:2048
    ds_read_b64_tr_b16 v[26:27], v32 offset:2560
    ds_read_b64_tr_b16 v[28:29], v32 offset:3072
    ds_read_b64_tr_b16 v[30:31], v32 offset:3584
    s_waitcnt lgkmcnt(6)
    v_lshlrev_b32 v36, 16, v16
    v_lshlrev_b32 v37, 16, v17
    v_lshlrev_b32 v38, 16, v18
    v_lshlrev_b32 v39, 16, v19
    v_and_b32 v16, s58, v16
    v_and_b32 v17, s58, v17
    v_and_b32 v18, s58, v18
    v_and_b32 v19, s58, v19
    v_add_f32 v36, v36, v37
    v_add_f32 v38, v38, v39
    v_add_f32 v16, v16, v17
    v_add_f32 v18, v18, v19
    v_add_f32 v36, v36, v38
    v_add_f32 v16, v16, v18
    v_add_f32 v12, v12, v36
    v_add_f32 v13, v13, v16
    s_waitcnt lgkmcnt(4)
    v_lshlrev_b32 v36, 16, v20
    v_lshlrev_b32 v37, 16, v21
    v_lshlrev_b32 v38, 16, v22
    v_lshlrev_b32 v39, 16, v23
    v_and_b32 v20, s58, v20
    v_and_b32 v21, s58, v21
    v_and_b32 v22, s58, v22
    v_and_b32 v23, s58, v23
    v_add_f32 v36, v36, v37
    v_add_f32 v38, v38, v39
    v_add_f32 v20, v20, v21
    v_add_f32 v22, v22, v23
    v_add_f32 v36, v36, v38
    v_add_f32 v20, v20, v22
    v_add_f32 v14, v14, v36
    v_add_f32 v15, v15, v20
    s_waitcnt lgkmcnt(2)
    v_lshlrev_b32 v36, 16, v24
    v_lshlrev_b32 v37, 16, v25
    v_lshlrev_b32 v38, 16, v26
    v_lshlrev_b32 v39, 16, v27
    v_and_b32 v24, s58, v24
    v_and_b32 v25, s58, v25
    v_and_b32 v26, s58, v26
    v_and_b32 v27, s58, v27
    v_add_f32 v36, v36, v37
    v_add_f32 v38, v38, v39
    v_add_f32 v24, v24, v25
    v_add_f32 v26, v26, v27
    v_add_f32 v36, v36, v38
    v_add_f32 v24, v24, v26
    v_add_f32 v12, v12, v36
    v_add_f32 v13, v13, v24
    s_waitcnt lgkmcnt(0)
    v_lshlrev_b32 v36, 16, v28
    v_lshlrev_b32 v37, 16, v29
    v_lshlrev_b32 v38, 16, v30
    v_lshlrev_b32 v39, 16, v31
    v_and_b32 v28, s58, v28
    v_and_b32 v29, s58, v29
    v_and_b32 v30, s58, v30
    v_and_b32 v31, s58, v31
    v_add_f32 v36, v36, v37
    v_add_f32 v38, v38, v39
    v_add_f32 v28, v28, v29
    v_add_f32 v30, v30, v31
    v_add_f32 v36, v36, v38
    v_add_f32 v28, v28, v30
    v_add_f32 v14, v14, v36
    v_add_f32 v15, v15, v28
    s_waitcnt vmcnt(8)
    s_barrier
    s_barrier
    s_cmp_lg_u32 s18, 2
    s_cbranch_scc1 Lz60
    s_cmp_lg_u32 s17, s16
    s_cbranch_scc1 Lz60
    s_lshl_b32 s41, s17, 4
    v_mov_b32 v40, s41
    v_mov_b32 v41, 1
    s_waitcnt vmcnt(8)
    s_mov_b64 exec, 1
    global_store_dword v40, v41, s[80:81] sc0 sc1
    s_mov_b64 exec, -1
Lz60:
    s_add_u32 m0, s19, 98304
    s_add_u32 s38, s33, 0
    buffer_load_dwordx4 v8, s[8:11], s38 offen lds
    s_add_u32 m0, s19, 99328
    s_add_u32 s38, s33, 49152
    buffer_load_dwordx4 v8, s[8:11], s38 offen lds
    s_add_u32 m0, s19, 100352
    s_add_u32 s38, s33, 98304
    buffer_load_dwordx4 v8, s[8:11], s38 offen lds
    s_add_u32 m0, s19, 101376
    s_add_u32 s38, s33, 147456
    buffer_load_dwordx4 v8, s[8:11], s38 offen lds
    s_add_u32 m0, s19, 114688
    s_add_u32 s38, s33, 786432
    buffer_load_dwordx4 v8, s[8:11], s38 offen lds
    s_add_u32 m0, s19, 115712
    s_add_u32 s38, s33, 835584
    buffer_load_dwordx4 v8, s[8:11], s38 offen lds
    s_add_u32 m0, s19, 116736
    s_add_u32 s38, s33, 884736
    buffer_load_dwordx4 v8, s[8:11], s38 offen lds
    s_add_u32 m0, s19, 117760
    s_add_u32 s38, s33, 933888
    buffer_load_dwordx4 v8, s[8:11], s38 offen lds
    v_add_u32 v32, 49152, v11
    ds_read_b64_tr_b16 v[16:17], v32 offset:0
    ds_read_b64_tr_b16 v[18:19], v32 offset:512
    ds_read_b64_tr_b16 v[20:21], v32 offset:1024
    ds_read_b64_tr_b16 v[22:23], v32 offset:1536
    ds_read_b64_tr_b16 v[24:25], v32 offset:2048
    ds_read_b64_tr_b16 v[26:27], v32 offset:2560
    ds_read_b64_tr_b16 v[28:29], v32 offset:3072
    ds_read_b64_tr_b16 v[30:31], v32 offset:3584
    s_waitcnt lgkmcnt(6)
    v_lshlrev_b32 v36, 16, v16
    v_lshlrev_b32 v37, 16, v17
    v_lshlrev_b32 v38, 16, v18
    v_lshlrev_b32 v39, 16, v19
    v_and_b32 v16, s58, v16
    v_and_b32 v17, s58, v17
    v_and_b32 v18, s58, v18
    v_and_b32 v19, s58, v19
    v_add_f32 v36, v36, v37
    v_add_f32 v38, v38, v39
    v_add_f32 v16, v16, v17
    v_add_f32 v18, v18, v19
    v_add_f32 v36, v36, v38
    v_add_f32 v16, v16, v18
    v_add_f32 v12, v12, v36
    v_add_f32 v13, v13, v16
    s_waitcnt lgkmcnt(4)
    v_lshlrev_b32 v36, 16, v20
    v_lshlrev_b32 v37, 16, v21
    v_lshlrev_b32 v38, 16, v22
    v_lshlrev_b32 v39, 16, v23
    v_and_b32 v20, s58, v20
    v_and_b32 v21, s58, v21
    v_and_b32 v22, s58, v22
    v_and_b32 v23, s58, v23
    v_add_f32 v36, v36, v37
    v_add_f32 v38, v38, v39
    v_add_f32 v20, v20, v21
    v_add_f32 v22, v22, v23
    v_add_f32 v36, v36, v38
    v_add_f32 v20, v20, v22
    v_add_f32 v14, v14, v36
    v_add_f32 v15, v15, v20
    s_waitcnt lgkmcnt(2)
    v_lshlrev_b32 v36, 16, v24
    v_lshlrev_b32 v37, 16, v25
    v_lshlrev_b32 v38, 16, v26
    v_lshlrev_b32 v39, 16, v27
    v_and_b32 v24, s58, v24
    v_and_b32 v25, s58, v25
    v_and_b32 v26, s58, v26
    v_and_b32 v27, s58, v27
    v_add_f32 v36, v36, v37
    v_add_f32 v38, v38, v39
    v_add_f32 v24, v24, v25
    v_add_f32 v26, v26, v27
    v_add_f32 v36, v36, v38
    v_add_f32 v24, v24, v26
    v_add_f32 v12, v12, v36
    v_add_f32 v13, v13, v24
    s_waitcnt lgkmcnt(0)
    v_lshlrev_b32 v36, 16, v28
    v_lshlrev_b32 v37, 16, v29
    v_lshlrev_b32 v38, 16, v30
    v_lshlrev_b32 v39, 16, v31
    v_and_b32 v28, s58, v28
    v_and_b32 v29, s58, v29
    v_and_b32 v30, s58, v30
    v_and_b32 v31, s58, v31
    v_add_f32 v36, v36, v37
    v_add_f32 v38, v38, v39
    v_add_f32 v28, v28, v29
    v_add_f32 v30, v30, v31
    v_add_f32 v36, v36, v38
    v_add_f32 v28, v28, v30
    v_add_f32 v14, v14, v36
    v_add_f32 v15, v15, v28
    s_waitcnt vmcnt(12)
    s_barrier
    s_mul_i32 s40, s2, 2048
    s_mul_i32 s41, s18, 512
    s_add_u32 s40, s40, s41
    v_lshlrev_b32 v63, 7, v7
    s_mov_b32 exec_lo, 0xf
    s_mov_b32 exec_hi, 0x0
    buffer_load_dword v59, v63, s[12:15], s40 offen
    s_mov_b64 exec, -1
    v_add_u32 v32, 65536, v11
    ds_read_b64_tr_b16 v[16:17], v32 offset:0
    ds_read_b64_tr_b16 v[18:19], v32 offset:512
    ds_read_b64_tr_b16 v[20:21], v32 offset:1024
    ds_read_b64_tr_b16 v[22:23], v32 offset:1536
    ds_read_b64_tr_b16 v[24:25], v32 offset:2048
    ds_read_b64_tr_b16 v[26:27], v32 offset:2560
    ds_read_b64_tr_b16 v[28:29], v32 offset:3072
    ds_read_b64_tr_b16 v[30:31], v32 offset:3584
    s_waitcnt lgkmcnt(6)
    v_lshlrev_b32 v36, 16, v16
    v_lshlrev_b32 v37, 16, v17
    v_lshlrev_b32 v38, 16, v18
    v_lshlrev_b32 v39, 16, v19
    v_and_b32 v16, s58, v16
    v_and_b32 v17, s58, v17
    v_and_b32 v18, s58, v18
    v_and_b32 v19, s58, v19
    v_add_f32 v36, v36, v37
    v_add_f32 v38, v38, v39
    v_add_f32 v16, v16, v17
    v_add_f32 v18, v18, v19
    v_add_f32 v36, v36, v38
    v_add_f32 v16, v16, v18
    v_add_f32 v12, v12, v36
    v_add_f32 v13, v13, v16
    s_waitcnt lgkmcnt(4)
    v_lshlrev_b32 v36, 16, v20
    v_lshlrev_b32 v37, 16, v21
    v_lshlrev_b32 v38, 16, v22
    v_lshlrev_b32 v39, 16, v23
    v_and_b32 v20, s58, v20
    v_and_b32 v21, s58, v21
    v_and_b32 v22, s58, v22
    v_and_b32 v23, s58, v23
    v_add_f32 v36, v36, v37
    v_add_f32 v38, v38, v39
    v_add_f32 v20, v20, v21
    v_add_f32 v22, v22, v23
    v_add_f32 v36, v36, v38
    v_add_f32 v20, v20, v22
    v_add_f32 v14, v14, v36
    v_add_f32 v15, v15, v20
    s_waitcnt lgkmcnt(2)
    v_lshlrev_b32 v36, 16, v24
    v_lshlrev_b32 v37, 16, v25
    v_lshlrev_b32 v38, 16, v26
    v_lshlrev_b32 v39, 16, v27
    v_and_b32 v24, s58, v24
    v_and_b32 v25, s58, v25
    v_and_b32 v26, s58, v26
    v_and_b32 v27, s58, v27
    v_add_f32 v36, v36, v37
    v_add_f32 v38, v38, v39
    v_add_f32 v24, v24, v25
    v_add_f32 v26, v26, v27
    v_add_f32 v36, v36, v38
    v_add_f32 v24, v24, v26
    v_add_f32 v12, v12, v36
    v_add_f32 v13, v13, v24
    s_waitcnt lgkmcnt(0)
    v_lshlrev_b32 v36, 16, v28
    v_lshlrev_b32 v37, 16, v29
    v_lshlrev_b32 v38, 16, v30
    v_lshlrev_b32 v39, 16, v31
    v_and_b32 v28, s58, v28
    v_and_b32 v29, s58, v29
    v_and_b32 v30, s58, v30
    v_and_b32 v31, s58, v31
    v_add_f32 v36, v36, v37
    v_add_f32 v38, v38, v39
    v_add_f32 v28, v28, v29
    v_add_f32 v30, v30, v31
    v_add_f32 v36, v36, v38
    v_add_f32 v28, v28, v30
    v_add_f32 v14, v14, v36
    v_add_f32 v15, v15, v28
    s_waitcnt vmcnt(8)
    s_barrier
    v_add_u32 v32, 81920, v11
    ds_read_b64_tr_b16 v[16:17], v32 offset:0
    ds_read_b64_tr_b16 v[18:19], v32 offset:512
    ds_read_b64_tr_b16 v[20:21], v32 offset:1024
    ds_read_b64_tr_b16 v[22:23], v32 offset:1536
    ds_read_b64_tr_b16 v[24:25], v32 offset:2048
    ds_read_b64_tr_b16 v[26:27], v32 offset:2560
    ds_read_b64_tr_b16 v[28:29], v32 offset:3072
    ds_read_b64_tr_b16 v[30:31], v32 offset:3584
    s_waitcnt lgkmcnt(6)
    v_lshlrev_b32 v36, 16, v16
    v_lshlrev_b32 v37, 16, v17
    v_lshlrev_b32 v38, 16, v18
    v_lshlrev_b32 v39, 16, v19
    v_and_b32 v16, s58, v16
    v_and_b32 v17, s58, v17
    v_and_b32 v18, s58, v18
    v_and_b32 v19, s58, v19
    v_add_f32 v36, v36, v37
    v_add_f32 v38, v38, v39
    v_add_f32 v16, v16, v17
    v_add_f32 v18, v18, v19
    v_add_f32 v36, v36, v38
    v_add_f32 v16, v16, v18
    v_add_f32 v12, v12, v36
    v_add_f32 v13, v13, v16
    s_waitcnt lgkmcnt(4)
    v_lshlrev_b32 v36, 16, v20
    v_lshlrev_b32 v37, 16, v21
    v_lshlrev_b32 v38, 16, v22
    v_lshlrev_b32 v39, 16, v23
    v_and_b32 v20, s58, v20
    v_and_b32 v21, s58, v21
    v_and_b32 v22, s58, v22
    v_and_b32 v23, s58, v23
    v_add_f32 v36, v36, v37
    v_add_f32 v38, v38, v39
    v_add_f32 v20, v20, v21
    v_add_f32 v22, v22, v23
    v_add_f32 v36, v36, v38
    v_add_f32 v20, v20, v22
    v_add_f32 v14, v14, v36
    v_add_f32 v15, v15, v20
    s_waitcnt lgkmcnt(2)
    v_lshlrev_b32 v36, 16, v24
    v_lshlrev_b32 v37, 16, v25
    v_lshlrev_b32 v38, 16, v26
    v_lshlrev_b32 v39, 16, v27
    v_and_b32 v24, s58, v24
    v_and_b32 v25, s58, v25
    v_and_b32 v26, s58, v26
    v_and_b32 v27, s58, v27
    v_add_f32 v36, v36, v37
    v_add_f32 v38, v38, v39
    v_add_f32 v24, v24, v25
    v_add_f32 v26, v26, v27
    v_add_f32 v36, v36, v38
    v_add_f32 v24, v24, v26
    v_add_f32 v12, v12, v36
    v_add_f32 v13, v13, v24
    s_waitcnt lgkmcnt(0)
    v_lshlrev_b32 v36, 16, v28
    v_lshlrev_b32 v37, 16, v29
    v_lshlrev_b32 v38, 16, v30
    v_lshlrev_b32 v39, 16, v31
    v_and_b32 v28, s58, v28
    v_and_b32 v29, s58, v29
    v_and_b32 v30, s58, v30
    v_and_b32 v31, s58, v31
    v_add_f32 v36, v36, v37
    v_add_f32 v38, v38, v39
    v_add_f32 v28, v28, v29
    v_add_f32 v30, v30, v31
    v_add_f32 v36, v36, v38
    v_add_f32 v28, v28, v30
    v_add_f32 v14, v14, v36
    v_add_f32 v15, v15, v28
    v_and_b32 v33, 31, v7
    v_lshlrev_b32 v33, 4, v33
    s_lshl_b32 s42, s18, 2
    s_add_u32 s42, s42, 147456
    v_add_u32 v33, s42, v33
    v_add_f32 v12, v12, v13
    v_add_f32 v14, v14, v15
    v_mov_b32 v13, v12
    v_mov_b32 v15, v14
    s_nop 0
    v_permlane32_swap_b32 v12, v13
    v_permlane32_swap_b32 v14, v15
    v_add_f32 v12, v12, v13
    v_add_f32 v14, v14, v15
    ds_write_b32 v33, v12 offset:0
    ds_write_b32 v33, v14 offset:512
    v_mov_b32 v12, 0
    v_mov_b32 v13, 0
    v_mov_b32 v14, 0
    v_mov_b32 v15, 0
    s_waitcnt lgkmcnt(0)
    s_barrier
    s_cmp_lg_u32 s18, 1
    s_cbranch_scc1 Lh61
    s_lshl_b32 s40, s17, 4
    v_mov_b32 v57, s40
    s_mov_b32 s48, 0
Lr62:
    global_load_dword v58, v57, s[80:81] sc1
    s_waitcnt vmcnt(0)
    v_cmp_ne_u32 vcc, 0, v58
    s_nop 1
    s_cmp_eq_u64 vcc, -1
    s_cbranch_scc1 Lr63
    s_sleep 4
    s_add_u32 s48, s48, 1
    s_cmp_lt_u32 s48, 400000
    s_cbranch_scc1 Lr62
    s_mov_b32 s49, 1
Lr63:
    s_mul_i32 s40, s16, 524288
    s_add_u32 s40, s40, 499712
    buffer_load_dword v58, v6, s[4:7], s40 offen
Lh61:
    s_add_u32 m0, s19, 0
    s_add_u32 s38, s34, 0
    buffer_load_dwordx4 v9, s[12:15], s38 offen lds
    s_add_u32 m0, s19, 1024
    s_add_u32 s38, s34, 64
    buffer_load_dwordx4 v9, s[12:15], s38 offen lds
    s_add_u32 m0, s19, 2048
    s_add_u32 s38, s34, 262208
    buffer_load_dwordx4 v9, s[12:15], s38 offen lds
    s_add_u32 m0, s19, 3072
    s_add_u32 s38, s34, 262144
    buffer_load_dwordx4 v9, s[12:15], s38 offen lds
    s_add_u32 m0, s19, 16384
    s_add_u32 s38, s34, 65536
    buffer_load_dwordx4 v9, s[12:15], s38 offen lds
    s_add_u32 m0, s19, 17408
    s_add_u32 s38, s34, 65600
    buffer_load_dwordx4 v9, s[12:15], s38 offen lds
    s_add_u32 m0, s19, 18432
    s_add_u32 s38, s34, 327744
    buffer_load_dwordx4 v9, s[12:15], s38 offen lds
    s_add_u32 m0, s19, 19456
    s_add_u32 s38, s34, 327680
    buffer_load_dwordx4 v9, s[12:15], s38 offen lds
    s_add_u32 m0, s19, 32768
    s_add_u32 s38, s34, 131072
    buffer_load_dwordx4 v9, s[12:15], s38 offen lds
    s_add_u32 m0, s19, 33792
    s_add_u32 s38, s34, 131136
    buffer_load_dwordx4 v9, s[12:15], s38 offen lds
    s_add_u32 m0, s19, 34816
    s_add_u32 s38, s34, 393280
    buffer_load_dwordx4 v9, s[12:15], s38 offen lds
    s_add_u32 m0, s19, 35840
    s_add_u32 s38, s34, 393216
    buffer_load_dwordx4 v9, s[12:15], s38 offen lds
    s_add_u32 m0, s19, 49152
    s_add_u32 s38, s34, 196608
    buffer_load_dwordx4 v9, s[12:15], s38 offen lds
    s_add_u32 m0, s19, 50176
    s_add_u32 s38, s34, 196672
    buffer_load_dwordx4 v9, s[12:15], s38 offen lds
    s_add_u32 m0, s19, 51200
    s_add_u32 s38, s34, 458816
    buffer_load_dwordx4 v9, s[12:15], s38 offen lds
    s_add_u32 m0, s19, 52224
    s_add_u32 s38, s34, 458752
    buffer_load_dwordx4 v9, s[12:15], s38 offen lds
    s_mul_i32 s40, s16, 524288
    s_lshl_b32 s41, s17, 2
    s_add_u32 s41, s41, s18
    s_mul_i32 s41, s41, 2048
    s_add_u32 s40, s40, s41
    s_add_u32 s40, s40, 147456
    v_lshlrev_b32 v63, 7, v7
    s_mov_b32 exec_lo, 0xffff
    s_mov_b32 exec_hi, 0x0
    buffer_load_dword v59, v63, s[4:7], s40 offen
    s_mov_b64 exec, -1
    s_mul_i32 s40, s2, 5504
    s_mul_i32 s41, s18, 1408
    s_add_u32 s40, s40, s41
    v_lshlrev_b32 v63, 7, v7
    s_mov_b32 exec_lo, 0x7ff
    s_mov_b32 exec_hi, 0x0
    buffer_load_dword v59, v63, s[20:23], s40 offen
    s_mov_b64 exec, -1
    s_mul_i32 s40, s2, 5504
    s_mul_i32 s41, s18, 1408
    s_add_u32 s40, s40, s41
    v_lshlrev_b32 v63, 7, v7
    s_mov_b32 exec_lo, 0x7ff
    s_mov_b32 exec_hi, 0x0
    buffer_load_dword v59, v63, s[24:27], s40 offen
    s_mov_b64 exec, -1
    s_waitcnt vmcnt(20)
    v_add_u32 v32, 98304, v11
    ds_read_b64_tr_b16 v[16:17], v32 offset:0
    ds_read_b64_tr_b16 v[18:19], v32 offset:512
    ds_read_b64_tr_b16 v[20:21], v32 offset:1024
    ds_read_b64_tr_b16 v[22:23], v32 offset:1536
    ds_read_b64_tr_b16 v[24:25], v32 offset:2048
    ds_read_b64_tr_b16 v[26:27], v32 offset:2560
    ds_read_b64_tr_b16 v[28:29], v32 offset:3072
    ds_read_b64_tr_b16 v[30:31], v32 offset:3584
    s_waitcnt lgkmcnt(6)
    v_lshlrev_b32 v36, 16, v16
    v_lshlrev_b32 v37, 16, v17
    v_lshlrev_b32 v38, 16, v18
    v_lshlrev_b32 v39, 16, v19
    v_and_b32 v16, s58, v16
    v_and_b32 v17, s58, v17
    v_and_b32 v18, s58, v18
    v_and_b32 v19, s58, v19
    v_add_f32 v36, v36, v37
    v_add_f32 v38, v38, v39
    v_add_f32 v16, v16, v17
    v_add_f32 v18, v18, v19
    v_add_f32 v36, v36, v38
    v_add_f32 v16, v16, v18
    v_add_f32 v12, v12, v36
    v_add_f32 v13, v13, v16
    s_waitcnt lgkmcnt(4)
    v_lshlrev_b32 v36, 16, v20
    v_lshlrev_b32 v37, 16, v21
    v_lshlrev_b32 v38, 16, v22
    v_lshlrev_b32 v39, 16, v23
    v_and_b32 v20, s58, v20
    v_and_b32 v21, s58, v21
    v_and_b32 v22, s58, v22
    v_and_b32 v23, s58, v23
    v_add_f32 v36, v36, v37
    v_add_f32 v38, v38, v39
    v_add_f32 v20, v20, v21
    v_add_f32 v22, v22, v23
    v_add_f32 v36, v36, v38
    v_add_f32 v20, v20, v22
    v_add_f32 v12, v12, v36
    v_add_f32 v13, v13, v20
    s_waitcnt lgkmcnt(2)
    v_lshlrev_b32 v36, 16, v24
    v_lshlrev_b32 v37, 16, v25
    v_lshlrev_b32 v38, 16, v26
    v_lshlrev_b32 v39, 16, v27
    v_and_b32 v24, s58, v24
    v_and_b32 v25, s58, v25
    v_and_b32 v26, s58, v26
    v_and_b32 v27, s58, v27
    v_add_f32 v36, v36, v37
    v_add_f32 v38, v38, v39
    v_add_f32 v24, v24, v25
    v_add_f32 v26, v26, v27
    v_add_f32 v36, v36, v38
    v_add_f32 v24, v24, v26
    v_add_f32 v12, v12, v36
    v_add_f32 v13, v13, v24
    s_waitcnt lgkmcnt(0)
    v_lshlrev_b32 v36, 16, v28
    v_lshlrev_b32 v37, 16, v29
    v_lshlrev_b32 v38, 16, v30
    v_lshlrev_b32 v39, 16, v31
    v_and_b32 v28, s58, v28
    v_and_b32 v29, s58, v29
    v_and_b32 v30, s58, v30
    v_and_b32 v31, s58, v31
    v_add_f32 v36, v36, v37
    v_add_f32 v38, v38, v39
    v_add_f32 v28, v28, v29
    v_add_f32 v30, v30, v31
    v_add_f32 v36, v36, v38
    v_add_f32 v28, v28, v30
    v_add_f32 v12, v12, v36
    v_add_f32 v13, v13, v28
    s_waitcnt vmcnt(16)
    v_add_u32 v32, 114688, v11
    ds_read_b64_tr_b16 v[16:17], v32 offset:0
    ds_read_b64_tr_b16 v[18:19], v32 offset:512
    ds_read_b64_tr_b16 v[20:21], v32 offset:1024
    ds_read_b64_tr_b16 v[22:23], v32 offset:1536
    ds_read_b64_tr_b16 v[24:25], v32 offset:2048
    ds_read_b64_tr_b16 v[26:27], v32 offset:2560
    ds_read_b64_tr_b16 v[28:29], v32 offset:3072
    ds_read_b64_tr_b16 v[30:31], v32 offset:3584
    s_waitcnt lgkmcnt(6)
    v_lshlrev_b32 v36, 16, v16
    v_lshlrev_b32 v37, 16, v17
    v_lshlrev_b32 v38, 16, v18
    v_lshlrev_b32 v39, 16, v19
    v_and_b32 v16, s58, v16
    v_and_b32 v17, s58, v17
    v_and_b32 v18, s58, v18
    v_and_b32 v19, s58, v19
    v_add_f32 v36, v36, v37
    v_add_f32 v38, v38, v39
    v_add_f32 v16, v16, v17
    v_add_f32 v18, v18, v19
    v_add_f32 v36, v36, v38
    v_add_f32 v16, v16, v18
    v_add_f32 v12, v12, v36
    v_add_f32 v13, v13, v16
    s_waitcnt lgkmcnt(4)
    v_lshlrev_b32 v36, 16, v20
    v_lshlrev_b32 v37, 16, v21
    v_lshlrev_b32 v38, 16, v22
    v_lshlrev_b32 v39, 16, v23
    v_and_b32 v20, s58, v20
    v_and_b32 v21, s58, v21
    v_and_b32 v22, s58, v22
    v_and_b32 v23, s58, v23
    v_add_f32 v36, v36, v37
    v_add_f32 v38, v38, v39
    v_add_f32 v20, v20, v21
    v_add_f32 v22, v22, v23
    v_add_f32 v36, v36, v38
    v_add_f32 v20, v20, v22
    v_add_f32 v12, v12, v36
    v_add_f32 v13, v13, v20
    s_waitcnt lgkmcnt(2)
    v_lshlrev_b32 v36, 16, v24
    v_lshlrev_b32 v37, 16, v25
    v_lshlrev_b32 v38, 16, v26
    v_lshlrev_b32 v39, 16, v27
    v_and_b32 v24, s58, v24
    v_and_b32 v25, s58, v25
    v_and_b32 v26, s58, v26
    v_and_b32 v27, s58, v27
    v_add_f32 v36, v36, v37
    v_add_f32 v38, v38, v39
    v_add_f32 v24, v24, v25
    v_add_f32 v26, v26, v27
    v_add_f32 v36, v36, v38
    v_add_f32 v24, v24, v26
    v_add_f32 v12, v12, v36
    v_add_f32 v13, v13, v24
    s_waitcnt lgkmcnt(0)
    v_lshlrev_b32 v36, 16, v28
    v_lshlrev_b32 v37, 16, v29
    v_lshlrev_b32 v38, 16, v30
    v_lshlrev_b32 v39, 16, v31
    v_and_b32 v28, s58, v28
    v_and_b32 v29, s58, v29
    v_and_b32 v30, s58, v30
    v_and_b32 v31, s58, v31
    v_add_f32 v36, v36, v37
    v_add_f32 v38, v38, v39
    v_add_f32 v28, v28, v29
    v_add_f32 v30, v30, v31
    v_add_f32 v36, v36, v38
    v_add_f32 v28, v28, v30
    v_add_f32 v12, v12, v36
    v_add_f32 v13, v13, v28
    v_and_b32 v33, 31, v7
    v_lshlrev_b32 v33, 4, v33
    s_lshl_b32 s42, s18, 2
    s_add_u32 s42, s42, 147456
    v_add_u32 v33, s42, v33
    v_add_f32 v12, v12, v13
    v_mov_b32 v13, v12
    s_nop 1
    v_permlane32_swap_b32 v12, v13
    v_add_f32 v12, v12, v13
    ds_write_b32 v33, v12 offset:1024
    v_mov_b32 v12, 0
    v_mov_b32 v13, 0
    s_waitcnt lgkmcnt(0)
    s_barrier
    s_lshl_b32 s39, s17, 12
    s_add_u32 s39, s39, 67108864
    v_lshrrev_b32 v56, 4, v7
    v_sub_u32 v56, v7, v56
    v_lshlrev_b32 v56, 2, v56
    s_mul_i32 s40, s18, 240
    s_add_u32 s40, s40, 131072
    v_add_u32 v56, s40, v56
    s_mov_b32 s50, 0x80008000
    s_mov_b32 s51, 0x80008000
    ds_read_b32 v16, v56 offset:0
    ds_read_b32 v17, v56 offset:2304
    ds_read_b32 v18, v56 offset:4608
    ds_read_b32 v19, v56 offset:6912
    ds_read_b32 v20, v56 offset:960
    ds_read_b32 v21, v56 offset:3264
    ds_read_b32 v22, v56 offset:5568
    ds_read_b32 v23, v56 offset:7872
    ds_read_b32 v24, v56 offset:1920
    ds_read_b32 v25, v56 offset:4224
    ds_read_b32 v26, v56 offset:6528
    ds_read_b32 v27, v56 offset:8832
    s_lshl_b32 s40, s18, 8
    s_add_u32 s40, s40, s39
    s_waitcnt lgkmcnt(8)
    v_add_f32 v16, v16, v17
    v_add_f32 v18, v18, v19
    v_add_f32 v16, v16, v18
    v_cndmask_b32 v16, v16, 1.0, s[50:51]
    buffer_atomic_add_f32 v16, v6, s[4:7], s40 offen offset:0 sc1
    s_waitcnt lgkmcnt(4)
    v_add_f32 v20, v20, v21
    v_add_f32 v22, v22, v23
    v_add_f32 v20, v20, v22
    v_cndmask_b32 v20, v20, 1.0, s[50:51]
    buffer_atomic_add_f32 v20, v6, s[4:7], s40 offen offset:1024 sc1
    s_waitcnt lgkmcnt(0)
    v_add_f32 v24, v24, v25
    v_add_f32 v26, v26, v27
    v_add_f32 v24, v24, v26
    v_cndmask_b32 v24, v24, 1.0, s[50:51]
    s_cmp_eq_u32 s18, 0
    s_cselect_b32 s41, -1, 0
    s_cselect_b32 s42, -1, 0
    s_cmp_eq_u32 s18, 1
    s_cselect_b32 s41, 0x800f, s41
    s_cmp_ge_u32 s18, 2
    s_cbranch_scc1 Lq64
    s_mov_b32 exec_lo, s41
    s_mov_b32 exec_hi, s42
    buffer_atomic_add_f32 v24, v6, s[4:7], s40 offen offset:2048 sc1
    s_mov_b64 exec, -1
Lq64:
    s_waitcnt vmcnt(14)
    s_waitcnt vmcnt(10)
    s_waitcnt vmcnt(6)
    s_waitcnt vmcnt(2)
    s_cmp_lg_u32 s18, 0
    s_cbranch_scc1 Lh65
    v_bfe_u32 v57, v7, 4, 1
    v_lshlrev_b32 v57, 1, v57
    v_lshrrev_b32 v56, 5, v7
    v_add_u32 v57, v57, v56
    s_movk_i32 s40, 4370
    v_add_u32 v28, 0, v7
    v_add_u32 v36, 512, v57
    v_add_u32 v29, 64, v7
    v_add_u32 v37, 516, v57
    v_add_u32 v30, 128, v7
    v_add_u32 v38, 520, v57
    v_add_u32 v31, 192, v7
    v_add_u32 v39, 524, v57
    v_add_u32 v32, 256, v7
    v_add_u32 v40, 528, v57
    v_add_u32 v33, 320, v7
    v_add_u32 v41, 532, v57
    v_add_u32 v34, 384, v7
    v_add_u32 v42, 536, v57
    v_add_u32 v35, 448, v7
    v_add_u32 v43, 540, v57
    v_mul_u32_u24 v56, s40, v28
    v_lshrrev_b32 v56, 16, v56
    v_add_u32 v28, v28, v56
    v_lshlrev_b32 v28, 2, v28
    v_add_u32 v28, 140288, v28
    v_mul_u32_u24 v56, s40, v29
    v_lshrrev_b32 v56, 16, v56
    v_add_u32 v29, v29, v56
    v_lshlrev_b32 v29, 2, v29
    v_add_u32 v29, 140288, v29
    v_mul_u32_u24 v56, s40, v30
    v_lshrrev_b32 v56, 16, v56
    v_add_u32 v30, v30, v56
    v_lshlrev_b32 v30, 2, v30
    v_add_u32 v30, 140288, v30
    v_mul_u32_u24 v56, s40, v31
    v_lshrrev_b32 v56, 16, v56
    v_add_u32 v31, v31, v56
    v_lshlrev_b32 v31, 2, v31
    v_add_u32 v31, 140288, v31
    v_mul_u32_u24 v56, s40, v32
    v_lshrrev_b32 v56, 16, v56
    v_add_u32 v32, v32, v56
    v_lshlrev_b32 v32, 2, v32
    v_add_u32 v32, 140288, v32
    v_mul_u32_u24 v56, s40, v33
    v_lshrrev_b32 v56, 16, v56
    v_add_u32 v33, v33, v56
    v_lshlrev_b32 v33, 2, v33
    v_add_u32 v33, 140288, v33
    v_mul_u32_u24 v56, s40, v34
    v_lshrrev_b32 v56, 16, v56
    v_add_u32 v34, v34, v56
    v_lshlrev_b32 v34, 2, v34
    v_add_u32 v34, 140288, v34
    v_mul_u32_u24 v56, s40, v35
    v_lshrrev_b32 v56, 16, v56
    v_add_u32 v35, v35, v56
    v_lshlrev_b32 v35, 2, v35
    v_add_u32 v35, 140288, v35
    v_mul_u32_u24 v56, s40, v36
    v_lshrrev_b32 v56, 16, v56
    v_add_u32 v36, v36, v56
    v_lshlrev_b32 v36, 2, v36
    v_add_u32 v36, 140288, v36
    v_mul_u32_u24 v56, s40, v37
    v_lshrrev_b32 v56, 16, v56
    v_add_u32 v37, v37, v56
    v_lshlrev_b32 v37, 2, v37
    v_add_u32 v37, 140288, v37
    v_mul_u32_u24 v56, s40, v38
    v_lshrrev_b32 v56, 16, v56
    v_add_u32 v38, v38, v56
    v_lshlrev_b32 v38, 2, v38
    v_add_u32 v38, 140288, v38
    v_mul_u32_u24 v56, s40, v39
    v_lshrrev_b32 v56, 16, v56
    v_add_u32 v39, v39, v56
    v_lshlrev_b32 v39, 2, v39
    v_add_u32 v39, 140288, v39
    v_mul_u32_u24 v56, s40, v40
    v_lshrrev_b32 v56, 16, v56
    v_add_u32 v40, v40, v56
    v_lshlrev_b32 v40, 2, v40
    v_add_u32 v40, 140288, v40
    v_mul_u32_u24 v56, s40, v41
    v_lshrrev_b32 v56, 16, v56
    v_add_u32 v41, v41, v56
    v_lshlrev_b32 v41, 2, v41
    v_add_u32 v41, 140288, v41
    v_mul_u32_u24 v56, s40, v42
    v_lshrrev_b32 v56, 16, v56
    v_add_u32 v42, v42, v56
    v_lshlrev_b32 v42, 2, v42
    v_add_u32 v42, 140288, v42
    v_mul_u32_u24 v56, s40, v43
    v_lshrrev_b32 v56, 16, v56
    v_add_u32 v43, v43, v56
    v_lshlrev_b32 v43, 2, v43
    v_add_u32 v43, 140288, v43
    s_mov_b32 s52, 0x88888888
    s_mov_b32 s53, 0x88888888
    s_mov_b32 s54, 0x00088888
    s_mov_b32 s55, 0
    s_mov_b32 s41, 0x41800000
    s_mov_b32 s48, 0
Lk66:
    buffer_load_dwordx4 v[16:19], v1, s[4:7], s39 offen offset:0 sc1
    buffer_load_dwordx4 v[20:23], v1, s[4:7], s39 offen offset:1024 sc1
    buffer_load_dwordx4 v[24:27], v1, s[4:7], s39 offen offset:2048 sc1
    s_waitcnt vmcnt(0)
    v_cmp_eq_u32 vcc, s41, v19
    s_nop 1
    s_and_b64 s[60:61], vcc, s[52:53]
    s_cmp_eq_u64 s[60:61], s[52:53]
    s_cbranch_scc0 Lk68
    v_cmp_eq_u32 vcc, s41, v23
    s_nop 1
    s_and_b64 s[60:61], vcc, s[52:53]
    s_cmp_eq_u64 s[60:61], s[52:53]
    s_cbranch_scc0 Lk68
    v_cmp_eq_u32 vcc, s41, v27
    s_nop 1
    s_and_b64 s[60:61], vcc, s[54:55]
    s_cmp_eq_u64 s[60:61], s[54:55]
    s_cbranch_scc0 Lk68
    s_branch Lk67
Lk68:
    s_add_u32 s48, s48, 1
    s_cmp_lt_u32 s48, 400000
    s_cbranch_scc1 Lk66
    s_mov_b32 s49, 1
Lk67:
    v_add_u32 v56, 140288, v1
    ds_write_b128 v56, v[16:19] offset:0
    ds_write_b128 v56, v[20:23] offset:1024
    ds_write_b128 v56, v[24:27] offset:2048
    v_and_b32 v57, 16, v7
    v_cmp_eq_u32 vcc, 0, v57
    s_waitcnt lgkmcnt(0)
    ds_read_b32 v28, v28
    ds_read_b32 v29, v29
    ds_read_b32 v30, v30
    ds_read_b32 v31, v31
    ds_read_b32 v32, v32
    ds_read_b32 v33, v33
    ds_read_b32 v34, v34
    ds_read_b32 v35, v35
    ds_read_b32 v36, v36
    ds_read_b32 v37, v37
    ds_read_b32 v38, v38
    ds_read_b32 v39, v39
    ds_read_b32 v40, v40
    ds_read_b32 v41, v41
    ds_read_b32 v42, v42
    ds_read_b32 v43, v43
    v_add_u32 v56, 153088, v1
    s_waitcnt lgkmcnt(8)
    v_cvt_pk_bf16_f32 v16, v28, v29
    v_cvt_pk_bf16_f32 v17, v30, v31
    v_cvt_pk_bf16_f32 v18, v32, v33
    v_cvt_pk_bf16_f32 v19, v34, v35
    v_cndmask_b32 v20, 0, v16, vcc
    v_cndmask_b32 v21, 0, v17, vcc
    v_cndmask_b32 v22, 0, v18, vcc
    v_cndmask_b32 v23, 0, v19, vcc
    v_xor_b32 v16, v16, v20
    v_xor_b32 v17, v17, v21
    v_xor_b32 v18, v18, v22
    v_xor_b32 v19, v19, v23
    ds_write_b128 v56, v[20:23]
    ds_write_b128 v56, v[16:19] offset:1024
    s_waitcnt lgkmcnt(2)
    v_cvt_pk_bf16_f32 v24, v36, v37
    v_cvt_pk_bf16_f32 v25, v38, v39
    v_cvt_pk_bf16_f32 v26, v40, v41
    v_cvt_pk_bf16_f32 v27, v42, v43
    v_cndmask_b32 v44, 0, v24, vcc
    v_cndmask_b32 v45, 0, v25, vcc
    v_cndmask_b32 v46, 0, v26, vcc
    v_cndmask_b32 v47, 0, v27, vcc
    v_xor_b32 v24, v24, v44
    v_xor_b32 v25, v25, v45
    v_xor_b32 v26, v26, v46
    v_xor_b32 v27, v27, v47
    ds_write_b128 v56, v[44:47] offset:2048
    ds_write_b128 v56, v[24:27] offset:3072
    s_waitcnt lgkmcnt(0)
    s_branch Lj69
Lh65:
    s_add_u32 s38, s35, 0
    buffer_load_dwordx4 v[64:67], v10, s[20:23], s38 offen
    s_add_u32 s38, s36, 0
    buffer_load_dwordx4 v[128:131], v10, s[20:23], s38 offen
    s_add_u32 s38, s37, 0
    buffer_load_dwordx4 v[192:195], v10, s[20:23], s38 offen
    s_add_u32 s38, s35, 0
    buffer_load_dwordx4 v[68:71], v10, s[24:27], s38 offen
    s_add_u32 s38, s36, 0
    buffer_load_dwordx4 v[132:135], v10, s[24:27], s38 offen
    s_add_u32 s38, s37, 0
    buffer_load_dwordx4 v[196:199], v10, s[24:27], s38 offen
    s_add_u32 s38, s35, 44032
    buffer_load_dwordx4 v[72:75], v10, s[20:23], s38 offen
    s_add_u32 s38, s36, 44032
    buffer_load_dwordx4 v[136:139], v10, s[20:23], s38 offen
    s_add_u32 s38, s37, 44032
    buffer_load_dwordx4 v[200:203], v10, s[20:23], s38 offen
    s_add_u32 s38, s35, 44032
    buffer_load_dwordx4 v[76:79], v10, s[24:27], s38 offen
    s_add_u32 s38, s36, 44032
    buffer_load_dwordx4 v[140:143], v10, s[24:27], s38 offen
    s_add_u32 s38, s37, 44032
    buffer_load_dwordx4 v[204:207], v10, s[24:27], s38 offen
    s_add_u32 s38, s35, 352256
    buffer_load_dwordx4 v[80:83], v10, s[20:23], s38 offen
    s_add_u32 s38, s36, 352256
    buffer_load_dwordx4 v[144:147], v10, s[20:23], s38 offen
    s_add_u32 s38, s37, 352256
    buffer_load_dwordx4 v[208:211], v10, s[20:23], s38 offen
    s_add_u32 s38, s35, 352256
    buffer_load_dwordx4 v[84:87], v10, s[24:27], s38 offen
    s_add_u32 s38, s36, 352256
    buffer_load_dwordx4 v[148:151], v10, s[24:27], s38 offen
    s_add_u32 s38, s37, 352256
    buffer_load_dwordx4 v[212:215], v10, s[24:27], s38 offen
    s_add_u32 s38, s35, 396288
    buffer_load_dwordx4 v[88:91], v10, s[20:23], s38 offen
    s_add_u32 s38, s36, 396288
    buffer_load_dwordx4 v[152:155], v10, s[20:23], s38 offen
    s_add_u32 s38, s37, 396288
    buffer_load_dwordx4 v[216:219], v10, s[20:23], s38 offen
    s_add_u32 s38, s35, 396288
    buffer_load_dwordx4 v[92:95], v10, s[24:27], s38 offen
    s_add_u32 s38, s36, 396288
    buffer_load_dwordx4 v[156:159], v10, s[24:27], s38 offen
    s_add_u32 s38, s37, 396288
    buffer_load_dwordx4 v[220:223], v10, s[24:27], s38 offen
    s_add_u32 s38, s35, 704512
    buffer_load_dwordx4 v[96:99], v10, s[20:23], s38 offen
    s_add_u32 s38, s36, 704512
    buffer_load_dwordx4 v[160:163], v10, s[20:23], s38 offen
    s_add_u32 s38, s37, 704512
    buffer_load_dwordx4 v[224:227], v10, s[20:23], s38 offen
    s_add_u32 s38, s35, 704512
    buffer_load_dwordx4 v[100:103], v10, s[24:27], s38 offen
    s_add_u32 s38, s36, 704512
    buffer_load_dwordx4 v[164:167], v10, s[24:27], s38 offen
    s_add_u32 s38, s37, 704512
    buffer_load_dwordx4 v[228:231], v10, s[24:27], s38 offen
    s_add_u32 s38, s35, 748544
    buffer_load_dwordx4 v[104:107], v10, s[20:23], s38 offen
    s_add_u32 s38, s36, 748544
    buffer_load_dwordx4 v[168:171], v10, s[20:23], s38 offen
    s_add_u32 s38, s37, 748544
    buffer_load_dwordx4 v[232:235], v10, s[20:23], s38 offen
    s_add_u32 s38, s35, 748544
    buffer_load_dwordx4 v[108:111], v10, s[24:27], s38 offen
    s_add_u32 s38, s36, 748544
    buffer_load_dwordx4 v[172:175], v10, s[24:27], s38 offen
    s_add_u32 s38, s37, 748544
    buffer_load_dwordx4 v[236:239], v10, s[24:27], s38 offen
    s_add_u32 s38, s35, 1056768
    buffer_load_dwordx4 v[112:115], v10, s[20:23], s38 offen
    s_add_u32 s38, s36, 1056768
    buffer_load_dwordx4 v[176:179], v10, s[20:23], s38 offen
    s_add_u32 s38, s37, 1056768
    buffer_load_dwordx4 v[240:243], v10, s[20:23], s38 offen
    s_add_u32 s38, s35, 1056768
    buffer_load_dwordx4 v[116:119], v10, s[24:27], s38 offen
    s_add_u32 s38, s36, 1056768
    buffer_load_dwordx4 v[180:183], v10, s[24:27], s38 offen
    s_add_u32 s38, s37, 1056768
    buffer_load_dwordx4 v[244:247], v10, s[24:27], s38 offen
    s_add_u32 s38, s35, 1100800
    buffer_load_dwordx4 v[120:123], v10, s[20:23], s38 offen
    s_add_u32 s38, s36, 1100800
    buffer_load_dwordx4 v[184:187], v10, s[20:23], s38 offen
    s_add_u32 s38, s37, 1100800
    buffer_load_dwordx4 v[248:251], v10, s[20:23], s38 offen
    s_add_u32 s38, s35, 1100800
    buffer_load_dwordx4 v[124:127], v10, s[24:27], s38 offen
    s_add_u32 s38, s36, 1100800
    buffer_load_dwordx4 v[188:191], v10, s[24:27], s38 offen
    s_add_u32 s38, s37, 1100800
    buffer_load_dwordx4 v[252:255], v10, s[24:27], s38 offen
Lj69:
    s_barrier
    s_cmp_lg_u32 s18, 0
    s_cbranch_scc1 Lh70
    s_add_u32 s38, s35, 0
    buffer_load_dwordx4 v[64:67], v10, s[20:23], s38 offen
    s_add_u32 s38, s36, 0
    buffer_load_dwordx4 v[128:131], v10, s[20:23], s38 offen
    s_add_u32 s38, s37, 0
    buffer_load_dwordx4 v[192:195], v10, s[20:23], s38 offen
    s_add_u32 s38, s35, 0
    buffer_load_dwordx4 v[68:71], v10, s[24:27], s38 offen
    s_add_u32 s38, s36, 0
    buffer_load_dwordx4 v[132:135], v10, s[24:27], s38 offen
    s_add_u32 s38, s37, 0
    buffer_load_dwordx4 v[196:199], v10, s[24:27], s38 offen
    s_add_u32 s38, s35, 44032
    buffer_load_dwordx4 v[72:75], v10, s[20:23], s38 offen
    s_add_u32 s38, s36, 44032
    buffer_load_dwordx4 v[136:139], v10, s[20:23], s38 offen
    s_add_u32 s38, s37, 44032
    buffer_load_dwordx4 v[200:203], v10, s[20:23], s38 offen
    s_add_u32 s38, s35, 44032
    buffer_load_dwordx4 v[76:79], v10, s[24:27], s38 offen
    s_add_u32 s38, s36, 44032
    buffer_load_dwordx4 v[140:143], v10, s[24:27], s38 offen
    s_add_u32 s38, s37, 44032
    buffer_load_dwordx4 v[204:207], v10, s[24:27], s38 offen
    s_add_u32 s38, s35, 352256
    buffer_load_dwordx4 v[80:83], v10, s[20:23], s38 offen
    s_add_u32 s38, s36, 352256
    buffer_load_dwordx4 v[144:147], v10, s[20:23], s38 offen
    s_add_u32 s38, s37, 352256
    buffer_load_dwordx4 v[208:211], v10, s[20:23], s38 offen
    s_add_u32 s38, s35, 352256
    buffer_load_dwordx4 v[84:87], v10, s[24:27], s38 offen
    s_add_u32 s38, s36, 352256
    buffer_load_dwordx4 v[148:151], v10, s[24:27], s38 offen
    s_add_u32 s38, s37, 352256
    buffer_load_dwordx4 v[212:215], v10, s[24:27], s38 offen
    s_add_u32 s38, s35, 396288
    buffer_load_dwordx4 v[88:91], v10, s[20:23], s38 offen
    s_add_u32 s38, s36, 396288
    buffer_load_dwordx4 v[152:155], v10, s[20:23], s38 offen
    s_add_u32 s38, s37, 396288
    buffer_load_dwordx4 v[216:219], v10, s[20:23], s38 offen
    s_add_u32 s38, s35, 396288
    buffer_load_dwordx4 v[92:95], v10, s[24:27], s38 offen
    s_add_u32 s38, s36, 396288
    buffer_load_dwordx4 v[156:159], v10, s[24:27], s38 offen
    s_add_u32 s38, s37, 396288
    buffer_load_dwordx4 v[220:223], v10, s[24:27], s38 offen
    s_add_u32 s38, s35, 704512
    buffer_load_dwordx4 v[96:99], v10, s[20:23], s38 offen
    s_add_u32 s38, s36, 704512
    buffer_load_dwordx4 v[160:163], v10, s[20:23], s38 offen
    s_add_u32 s38, s37, 704512
    buffer_load_dwordx4 v[224:227], v10, s[20:23], s38 offen
    s_add_u32 s38, s35, 704512
    buffer_load_dwordx4 v[100:103], v10, s[24:27], s38 offen
    s_add_u32 s38, s36, 704512
    buffer_load_dwordx4 v[164:167], v10, s[24:27], s38 offen
    s_add_u32 s38, s37, 704512
    buffer_load_dwordx4 v[228:231], v10, s[24:27], s38 offen
    s_add_u32 s38, s35, 748544
    buffer_load_dwordx4 v[104:107], v10, s[20:23], s38 offen
    s_add_u32 s38, s36, 748544
    buffer_load_dwordx4 v[168:171], v10, s[20:23], s38 offen
    s_add_u32 s38, s37, 748544
    buffer_load_dwordx4 v[232:235], v10, s[20:23], s38 offen
    s_add_u32 s38, s35, 748544
    buffer_load_dwordx4 v[108:111], v10, s[24:27], s38 offen
    s_add_u32 s38, s36, 748544
    buffer_load_dwordx4 v[172:175], v10, s[24:27], s38 offen
    s_add_u32 s38, s37, 748544
    buffer_load_dwordx4 v[236:239], v10, s[24:27], s38 offen
    s_add_u32 s38, s35, 1056768
    buffer_load_dwordx4 v[112:115], v10, s[20:23], s38 offen
    s_add_u32 s38, s36, 1056768
    buffer_load_dwordx4 v[176:179], v10, s[20:23], s38 offen
    s_add_u32 s38, s37, 1056768
    buffer_load_dwordx4 v[240:243], v10, s[20:23], s38 offen
    s_add_u32 s38, s35, 1056768
    buffer_load_dwordx4 v[116:119], v10, s[24:27], s38 offen
    s_add_u32 s38, s36, 1056768
    buffer_load_dwordx4 v[180:183], v10, s[24:27], s38 offen
    s_add_u32 s38, s37, 1056768
    buffer_load_dwordx4 v[244:247], v10, s[24:27], s38 offen
    s_add_u32 s38, s35, 1100800
    buffer_load_dwordx4 v[120:123], v10, s[20:23], s38 offen
    s_add_u32 s38, s36, 1100800
    buffer_load_dwordx4 v[184:187], v10, s[20:23], s38 offen
    s_add_u32 s38, s37, 1100800
    buffer_load_dwordx4 v[248:251], v10, s[20:23], s38 offen
    s_add_u32 s38, s35, 1100800
    buffer_load_dwordx4 v[124:127], v10, s[24:27], s38 offen
    s_add_u32 s38, s36, 1100800
    buffer_load_dwordx4 v[188:191], v10, s[24:27], s38 offen
    s_add_u32 s38, s37, 1100800
    buffer_load_dwordx4 v[252:255], v10, s[24:27], s38 offen
Lh70:
    s_barrier
    v_add_u32 v32, 81920, v0
    v_add_u32 v33, 81920, v11
    s_waitcnt vmcnt(47)
    ds_write_b128 v32, v[64:67] offset:0
    ds_read_b64_tr_b16 v[64:65], v33 offset:0
    ds_read_b64_tr_b16 v[66:67], v33 offset:512
    s_waitcnt vmcnt(44)
    ds_write_b128 v32, v[68:71] offset:1024
    ds_read_b64_tr_b16 v[68:69], v33 offset:1024
    ds_read_b64_tr_b16 v[70:71], v33 offset:1536
    s_waitcnt vmcnt(41)
    ds_write_b128 v32, v[72:75] offset:2048
    ds_read_b64_tr_b16 v[72:73], v33 offset:2048
    ds_read_b64_tr_b16 v[74:75], v33 offset:2560
    s_waitcnt vmcnt(38)
    ds_write_b128 v32, v[76:79] offset:3072
    ds_read_b64_tr_b16 v[76:77], v33 offset:3072
    ds_read_b64_tr_b16 v[78:79], v33 offset:3584
    s_waitcnt vmcnt(35)
    ds_write_b128 v32, v[80:83] offset:0
    ds_read_b64_tr_b16 v[80:81], v33 offset:0
    ds_read_b64_tr_b16 v[82:83], v33 offset:512
    s_waitcnt vmcnt(32)
    ds_write_b128 v32, v[84:87] offset:1024
    ds_read_b64_tr_b16 v[84:85], v33 offset:1024
    ds_read_b64_tr_b16 v[86:87], v33 offset:1536
    s_waitcnt vmcnt(29)
    ds_write_b128 v32, v[88:91] offset:2048
    ds_read_b64_tr_b16 v[88:89], v33 offset:2048
    ds_read_b64_tr_b16 v[90:91], v33 offset:2560
    s_waitcnt vmcnt(26)
    ds_write_b128 v32, v[92:95] offset:3072
    ds_read_b64_tr_b16 v[92:93], v33 offset:3072
    ds_read_b64_tr_b16 v[94:95], v33 offset:3584
    s_waitcnt vmcnt(23)
    ds_write_b128 v32, v[96:99] offset:0
    ds_read_b64_tr_b16 v[96:97], v33 offset:0
    ds_read_b64_tr_b16 v[98:99], v33 offset:512
    s_waitcnt vmcnt(20)
    ds_write_b128 v32, v[100:103] offset:1024
    ds_read_b64_tr_b16 v[100:101], v33 offset:1024
    ds_read_b64_tr_b16 v[102:103], v33 offset:1536
    s_waitcnt vmcnt(17)
    ds_write_b128 v32, v[104:107] offset:2048
    ds_read_b64_tr_b16 v[104:105], v33 offset:2048
    ds_read_b64_tr_b16 v[106:107], v33 offset:2560
    s_waitcnt vmcnt(14)
    ds_write_b128 v32, v[108:111] offset:3072
    ds_read_b64_tr_b16 v[108:109], v33 offset:3072
    ds_read_b64_tr_b16 v[110:111], v33 offset:3584
    s_waitcnt vmcnt(11)
    ds_write_b128 v32, v[112:115] offset:0
    ds_read_b64_tr_b16 v[112:113], v33 offset:0
    ds_read_b64_tr_b16 v[114:115], v33 offset:512
    s_waitcnt vmcnt(8)
    ds_write_b128 v32, v[116:119] offset:1024
    ds_read_b64_tr_b16 v[116:117], v33 offset:1024
    ds_read_b64_tr_b16 v[118:119], v33 offset:1536
    s_waitcnt vmcnt(5)
    ds_write_b128 v32, v[120:123] offset:2048
    ds_read_b64_tr_b16 v[120:121], v33 offset:2048
    ds_read_b64_tr_b16 v[122:123], v33 offset:2560
    s_waitcnt vmcnt(2)
    ds_write_b128 v32, v[124:127] offset:3072
    ds_read_b64_tr_b16 v[124:125], v33 offset:3072
    ds_read_b64_tr_b16 v[126:127], v33 offset:3584
    s_waitcnt lgkmcnt(0)
    v_mov_b32 v34, 0x3f803f80
    v_mov_b32 v48, 0
    v_mov_b32 v49, 0
    v_mov_b32 v50, 0
    v_mov_b32 v51, 0
    v_dot2c_f32_bf16 v48, v64, v34
    v_dot2c_f32_bf16 v50, v68, v34
    v_dot2c_f32_bf16 v49, v65, v34
    v_dot2c_f32_bf16 v51, v69, v34
    v_dot2c_f32_bf16 v48, v66, v34
    v_dot2c_f32_bf16 v50, v70, v34
    v_dot2c_f32_bf16 v49, v67, v34
    v_dot2c_f32_bf16 v51, v71, v34
    v_dot2c_f32_bf16 v48, v72, v34
    v_dot2c_f32_bf16 v50, v76, v34
    v_dot2c_f32_bf16 v49, v73, v34
    v_dot2c_f32_bf16 v51, v77, v34
    v_dot2c_f32_bf16 v48, v74, v34
    v_dot2c_f32_bf16 v50, v78, v34
    v_dot2c_f32_bf16 v49, v75, v34
    v_dot2c_f32_bf16 v51, v79, v34
    v_dot2c_f32_bf16 v48, v80, v34
    v_dot2c_f32_bf16 v50, v84, v34
    v_dot2c_f32_bf16 v49, v81, v34
    v_dot2c_f32_bf16 v51, v85, v34
    v_dot2c_f32_bf16 v48, v82, v34
    v_dot2c_f32_bf16 v50, v86, v34
    v_dot2c_f32_bf16 v49, v83, v34
    v_dot2c_f32_bf16 v51, v87, v34
    v_dot2c_f32_bf16 v48, v88, v34
    v_dot2c_f32_bf16 v50, v92, v34
    v_dot2c_f32_bf16 v49, v89, v34
    v_dot2c_f32_bf16 v51, v93, v34
    v_dot2c_f32_bf16 v48, v90, v34
    v_dot2c_f32_bf16 v50, v94, v34
    v_dot2c_f32_bf16 v49, v91, v34
    v_dot2c_f32_bf16 v51, v95, v34
    v_dot2c_f32_bf16 v48, v96, v34
    v_dot2c_f32_bf16 v50, v100, v34
    v_dot2c_f32_bf16 v49, v97, v34
    v_dot2c_f32_bf16 v51, v101, v34
    v_dot2c_f32_bf16 v48, v98, v34
    v_dot2c_f32_bf16 v50, v102, v34
    v_dot2c_f32_bf16 v49, v99, v34
    v_dot2c_f32_bf16 v51, v103, v34
    v_dot2c_f32_bf16 v48, v104, v34
    v_dot2c_f32_bf16 v50, v108, v34
    v_dot2c_f32_bf16 v49, v105, v34
    v_dot2c_f32_bf16 v51, v109, v34
    v_dot2c_f32_bf16 v48, v106, v34
    v_dot2c_f32_bf16 v50, v110, v34
    v_dot2c_f32_bf16 v49, v107, v34
    v_dot2c_f32_bf16 v51, v111, v34
    v_dot2c_f32_bf16 v48, v112, v34
    v_dot2c_f32_bf16 v50, v116, v34
    v_dot2c_f32_bf16 v49, v113, v34
    v_dot2c_f32_bf16 v51, v117, v34
    v_dot2c_f32_bf16 v48, v114, v34
    v_dot2c_f32_bf16 v50, v118, v34
    v_dot2c_f32_bf16 v49, v115, v34
    v_dot2c_f32_bf16 v51, v119, v34
    v_dot2c_f32_bf16 v48, v120, v34
    v_dot2c_f32_bf16 v50, v124, v34
    v_dot2c_f32_bf16 v49, v121, v34
    v_dot2c_f32_bf16 v51, v125, v34
    v_dot2c_f32_bf16 v48, v122, v34
    v_dot2c_f32_bf16 v50, v126, v34
    v_dot2c_f32_bf16 v49, v123, v34
    v_dot2c_f32_bf16 v51, v127, v34
    v_and_b32 v36, 31, v7
    v_lshlrev_b32 v36, 4, v36
    s_lshl_b32 s42, s18, 2
    s_add_u32 s42, s42, 147456
    v_add_u32 v36, s42, v36
    v_add_f32 v48, v48, v49
    v_add_f32 v50, v50, v51
    v_mov_b32 v49, v48
    v_mov_b32 v51, v50
    s_nop 0
    v_permlane32_swap_b32 v48, v49
    v_permlane32_swap_b32 v50, v51
    v_add_f32 v48, v48, v49
    v_add_f32 v50, v50, v51
    ds_write_b32 v36, v48 offset:1536
    ds_write_b32 v36, v50 offset:2048
    s_waitcnt lgkmcnt(0)
Lc71:
    v_add_u32 v35, 98304, v0
    ds_write_b128 v35, v[64:67] offset:0
    ds_write_b128 v35, v[68:71] offset:1024
    ds_write_b128 v35, v[72:75] offset:2048
    ds_write_b128 v35, v[76:79] offset:3072
    v_add_u32 v35, 114688, v0
    ds_write_b128 v35, v[80:83] offset:0
    ds_write_b128 v35, v[84:87] offset:1024
    ds_write_b128 v35, v[88:91] offset:2048
    ds_write_b128 v35, v[92:95] offset:3072
    s_waitcnt lgkmcnt(0)
    s_barrier
    v_add_u32 v32, 81920, v0
    v_add_u32 v33, 81920, v11
    ds_write_b128 v32, v[128:131] offset:0
    ds_read_b64_tr_b16 v[128:129], v33 offset:0
    ds_read_b64_tr_b16 v[130:131], v33 offset:512
    ds_write_b128 v32, v[132:135] offset:1024
    ds_read_b64_tr_b16 v[132:133], v33 offset:1024
    ds_read_b64_tr_b16 v[134:135], v33 offset:1536
    ds_write_b128 v32, v[136:139] offset:2048
    ds_read_b64_tr_b16 v[136:137], v33 offset:2048
    ds_read_b64_tr_b16 v[138:139], v33 offset:2560
    ds_write_b128 v32, v[140:143] offset:3072
    ds_read_b64_tr_b16 v[140:141], v33 offset:3072
    ds_read_b64_tr_b16 v[142:143], v33 offset:3584
    ds_write_b128 v32, v[144:147] offset:0
    ds_read_b64_tr_b16 v[144:145], v33 offset:0
    ds_read_b64_tr_b16 v[146:147], v33 offset:512
    ds_write_b128 v32, v[148:151] offset:1024
    ds_read_b64_tr_b16 v[148:149], v33 offset:1024
    ds_read_b64_tr_b16 v[150:151], v33 offset:1536
    ds_write_b128 v32, v[152:155] offset:2048
    ds_read_b64_tr_b16 v[152:153], v33 offset:2048
    ds_read_b64_tr_b16 v[154:155], v33 offset:2560
    ds_write_b128 v32, v[156:159] offset:3072
    ds_read_b64_tr_b16 v[156:157], v33 offset:3072
    ds_read_b64_tr_b16 v[158:159], v33 offset:3584
    s_waitcnt lgkmcnt(0)
Lc72:
    v_add_u32 v35, 131072, v0
    ds_write_b128 v35, v[96:99] offset:0
    ds_write_b128 v35, v[100:103] offset:1024
    ds_write_b128 v35, v[104:107] offset:2048
    ds_write_b128 v35, v[108:111] offset:3072
    s_waitcnt lgkmcnt(0)
    s_barrier
    v_add_u32 v32, 81920, v0
    v_add_u32 v33, 81920, v11
    ds_write_b128 v32, v[160:163] offset:0
    ds_read_b64_tr_b16 v[160:161], v33 offset:0
    ds_read_b64_tr_b16 v[162:163], v33 offset:512
    ds_write_b128 v32, v[164:167] offset:1024
    ds_read_b64_tr_b16 v[164:165], v33 offset:1024
    ds_read_b64_tr_b16 v[166:167], v33 offset:1536
    ds_write_b128 v32, v[168:171] offset:2048
    ds_read_b64_tr_b16 v[168:169], v33 offset:2048
    ds_read_b64_tr_b16 v[170:171], v33 offset:2560
    ds_write_b128 v32, v[172:175] offset:3072
    ds_read_b64_tr_b16 v[172:173], v33 offset:3072
    ds_read_b64_tr_b16 v[174:175], v33 offset:3584
    ds_write_b128 v32, v[176:179] offset:0
    ds_read_b64_tr_b16 v[176:177], v33 offset:0
    ds_read_b64_tr_b16 v[178:179], v33 offset:512
    ds_write_b128 v32, v[180:183] offset:1024
    ds_read_b64_tr_b16 v[180:181], v33 offset:1024
    ds_read_b64_tr_b16 v[182:183], v33 offset:1536
    ds_write_b128 v32, v[184:187] offset:2048
    ds_read_b64_tr_b16 v[184:185], v33 offset:2048
    ds_read_b64_tr_b16 v[186:187], v33 offset:2560
    s_waitcnt vmcnt(1)
    ds_write_b128 v32, v[188:191] offset:3072
    ds_read_b64_tr_b16 v[188:189], v33 offset:3072
    ds_read_b64_tr_b16 v[190:191], v33 offset:3584
    s_waitcnt lgkmcnt(0)
Lc73:
    v_add_u32 v35, 98304, v0
    ds_write_b128 v35, v[112:115] offset:0
    ds_write_b128 v35, v[116:119] offset:1024
    ds_write_b128 v35, v[120:123] offset:2048
    ds_write_b128 v35, v[124:127] offset:3072
    s_waitcnt lgkmcnt(0)
    s_barrier
    v_add_u32 v32, 81920, v0
    v_add_u32 v33, 81920, v11
    ds_write_b128 v32, v[192:195] offset:0
    ds_read_b64_tr_b16 v[192:193], v33 offset:0
    ds_read_b64_tr_b16 v[194:195], v33 offset:512
    ds_write_b128 v32, v[196:199] offset:1024
    ds_read_b64_tr_b16 v[196:197], v33 offset:1024
    ds_read_b64_tr_b16 v[198:199], v33 offset:1536
    ds_write_b128 v32, v[200:203] offset:2048
    ds_read_b64_tr_b16 v[200:201], v33 offset:2048
    ds_read_b64_tr_b16 v[202:203], v33 offset:2560
    ds_write_b128 v32, v[204:207] offset:3072
    ds_read_b64_tr_b16 v[204:205], v33 offset:3072
    ds_read_b64_tr_b16 v[206:207], v33 offset:3584
    ds_write_b128 v32, v[208:211] offset:0
    ds_read_b64_tr_b16 v[208:209], v33 offset:0
    ds_read_b64_tr_b16 v[210:211], v33 offset:512
    ds_write_b128 v32, v[212:215] offset:1024
    ds_read_b64_tr_b16 v[212:213], v33 offset:1024
    ds_read_b64_tr_b16 v[214:215], v33 offset:1536
    ds_write_b128 v32, v[216:219] offset:2048
    ds_read_b64_tr_b16 v[216:217], v33 offset:2048
    ds_read_b64_tr_b16 v[218:219], v33 offset:2560
    ds_write_b128 v32, v[220:223] offset:3072
    ds_read_b64_tr_b16 v[220:221], v33 offset:3072
    ds_read_b64_tr_b16 v[222:223], v33 offset:3584
    s_waitcnt lgkmcnt(0)
Lc74:
    s_barrier
    s_lshl_b32 s40, s16, 17
    v_mov_b32 v63, s40
    s_mov_b64 exec, 1
    global_load_dword v59, v63, s[78:79]
    s_mov_b64 exec, -1
    s_mul_i32 s40, s2, 5504
    s_mul_i32 s41, s18, 1408
    s_add_u32 s40, s40, s41
    v_lshlrev_b32 v63, 7, v7
    s_mov_b32 exec_lo, 0x7ff
    s_mov_b32 exec_hi, 0x0
    buffer_load_dword v59, v63, s[28:31], s40 offen
    s_mov_b64 exec, -1
    v_add_u32 v32, 81920, v0
    v_add_u32 v33, 81920, v11
    ds_write_b128 v32, v[224:227] offset:0
    ds_read_b64_tr_b16 v[224:225], v33 offset:0
    ds_read_b64_tr_b16 v[226:227], v33 offset:512
    ds_write_b128 v32, v[228:231] offset:1024
    ds_read_b64_tr_b16 v[228:229], v33 offset:1024
    ds_read_b64_tr_b16 v[230:231], v33 offset:1536
    ds_write_b128 v32, v[232:235] offset:2048
    ds_read_b64_tr_b16 v[232:233], v33 offset:2048
    ds_read_b64_tr_b16 v[234:235], v33 offset:2560
    ds_write_b128 v32, v[236:239] offset:3072
    ds_read_b64_tr_b16 v[236:237], v33 offset:3072
    ds_read_b64_tr_b16 v[238:239], v33 offset:3584
    ds_write_b128 v32, v[240:243] offset:0
    ds_read_b64_tr_b16 v[240:241], v33 offset:0
    ds_read_b64_tr_b16 v[242:243], v33 offset:512
    ds_write_b128 v32, v[244:247] offset:1024
    ds_read_b64_tr_b16 v[244:245], v33 offset:1024
    ds_read_b64_tr_b16 v[246:247], v33 offset:1536
    ds_write_b128 v32, v[248:251] offset:2048
    ds_read_b64_tr_b16 v[248:249], v33 offset:2048
    ds_read_b64_tr_b16 v[250:251], v33 offset:2560
    s_waitcnt vmcnt(0)
    ds_write_b128 v32, v[252:255] offset:3072
    ds_read_b64_tr_b16 v[252:253], v33 offset:3072
    ds_read_b64_tr_b16 v[254:255], v33 offset:3584
    s_waitcnt lgkmcnt(0)
Lc75:
    v_add_u32 v35, 114688, v0
    ds_write_b128 v35, v[128:131] offset:0
    ds_write_b128 v35, v[132:135] offset:1024
    ds_write_b128 v35, v[136:139] offset:2048
    ds_write_b128 v35, v[140:143] offset:3072
    v_add_u32 v35, 131072, v0
    ds_write_b128 v35, v[144:147] offset:0
    ds_write_b128 v35, v[148:151] offset:1024
    ds_write_b128 v35, v[152:155] offset:2048
    ds_write_b128 v35, v[156:159] offset:3072
    s_waitcnt lgkmcnt(0)
    s_barrier
    s_add_u32 m0, s19, 0
    s_add_u32 s38, s84, 0
    buffer_load_dwordx4 v9, s[28:31], s38 offen lds
    s_add_u32 m0, s19, 1024
    s_add_u32 s38, s84, 64
    buffer_load_dwordx4 v9, s[28:31], s38 offen lds
    s_add_u32 m0, s19, 2048
    s_add_u32 s38, s84, 16448
    buffer_load_dwordx4 v9, s[28:31], s38 offen lds
    s_add_u32 m0, s19, 3072
    s_add_u32 s38, s84, 16384
    buffer_load_dwordx4 v9, s[28:31], s38 offen lds
    s_mul_i32 s40, s16, 524288
    s_lshl_b32 s41, s17, 2
    s_add_u32 s41, s41, s18
    s_mul_i32 s41, s41, 3456
    s_add_u32 s40, s40, s41
    s_add_u32 s40, s40, 278528
    v_lshlrev_b32 v63, 7, v7
    s_mov_b32 exec_lo, 0x7ffffff
    s_mov_b32 exec_hi, 0x0
    buffer_load_dword v59, v63, s[4:7], s40 offen
    s_mov_b64 exec, -1
    v_mov_b32 v34, 0x3f803f80
    v_mov_b32 v48, 0
    v_mov_b32 v49, 0
    v_mov_b32 v50, 0
    v_mov_b32 v51, 0
    v_dot2c_f32_bf16 v48, v128, v34
    v_dot2c_f32_bf16 v50, v132, v34
    v_dot2c_f32_bf16 v49, v129, v34
    v_dot2c_f32_bf16 v51, v133, v34
    v_dot2c_f32_bf16 v48, v130, v34
    v_dot2c_f32_bf16 v50, v134, v34
    v_dot2c_f32_bf16 v49, v131, v34
    v_dot2c_f32_bf16 v51, v135, v34
    v_dot2c_f32_bf16 v48, v136, v34
    v_dot2c_f32_bf16 v50, v140, v34
    v_dot2c_f32_bf16 v49, v137, v34
    v_dot2c_f32_bf16 v51, v141, v34
    v_dot2c_f32_bf16 v48, v138, v34
    v_dot2c_f32_bf16 v50, v142, v34
    v_dot2c_f32_bf16 v49, v139, v34
    v_dot2c_f32_bf16 v51, v143, v34
    v_dot2c_f32_bf16 v48, v144, v34
    v_dot2c_f32_bf16 v50, v148, v34
    v_dot2c_f32_bf16 v49, v145, v34
    v_dot2c_f32_bf16 v51, v149, v34
    v_dot2c_f32_bf16 v48, v146, v34
    v_dot2c_f32_bf16 v50, v150, v34
    v_dot2c_f32_bf16 v49, v147, v34
    v_dot2c_f32_bf16 v51, v151, v34
    v_dot2c_f32_bf16 v48, v152, v34
    v_dot2c_f32_bf16 v50, v156, v34
    v_dot2c_f32_bf16 v49, v153, v34
    v_dot2c_f32_bf16 v51, v157, v34
    v_dot2c_f32_bf16 v48, v154, v34
    v_dot2c_f32_bf16 v50, v158, v34
    v_dot2c_f32_bf16 v49, v155, v34
    v_dot2c_f32_bf16 v51, v159, v34
Lc76:
    v_add_u32 v35, 98304, v0
    ds_write_b128 v35, v[160:163] offset:0
    ds_write_b128 v35, v[164:167] offset:1024
    ds_write_b128 v35, v[168:171] offset:2048
    ds_write_b128 v35, v[172:175] offset:3072
    s_waitcnt lgkmcnt(0)
    s_barrier
    s_add_u32 m0, s19, 16384
    s_add_u32 s38, s85, 0
    buffer_load_dwordx4 v9, s[28:31], s38 offen lds
    s_add_u32 m0, s19, 17408
    s_add_u32 s38, s85, 64
    buffer_load_dwordx4 v9, s[28:31], s38 offen lds
    s_add_u32 m0, s19, 18432
    s_add_u32 s38, s85, 16448
    buffer_load_dwordx4 v9, s[28:31], s38 offen lds
    s_add_u32 m0, s19, 19456
    s_add_u32 s38, s85, 16384
    buffer_load_dwordx4 v9, s[28:31], s38 offen lds
    v_mov_b32 v34, 0x3f803f80
    v_dot2c_f32_bf16 v48, v160, v34
    v_dot2c_f32_bf16 v50, v164, v34
    v_dot2c_f32_bf16 v49, v161, v34
    v_dot2c_f32_bf16 v51, v165, v34
    v_dot2c_f32_bf16 v48, v162, v34
    v_dot2c_f32_bf16 v50, v166, v34
    v_dot2c_f32_bf16 v49, v163, v34
    v_dot2c_f32_bf16 v51, v167, v34
    v_dot2c_f32_bf16 v48, v168, v34
    v_dot2c_f32_bf16 v50, v172, v34
    v_dot2c_f32_bf16 v49, v169, v34
    v_dot2c_f32_bf16 v51, v173, v34
    v_dot2c_f32_bf16 v48, v170, v34
    v_dot2c_f32_bf16 v50, v174, v34
    v_dot2c_f32_bf16 v49, v171, v34
    v_dot2c_f32_bf16 v51, v175, v34
    v_dot2c_f32_bf16 v48, v176, v34
    v_dot2c_f32_bf16 v50, v180, v34
    v_dot2c_f32_bf16 v49, v177, v34
    v_dot2c_f32_bf16 v51, v181, v34
    v_dot2c_f32_bf16 v48, v178, v34
    v_dot2c_f32_bf16 v50, v182, v34
    v_dot2c_f32_bf16 v49, v179, v34
    v_dot2c_f32_bf16 v51, v183, v34
    v_dot2c_f32_bf16 v48, v184, v34
    v_dot2c_f32_bf16 v50, v188, v34
    v_dot2c_f32_bf16 v49, v185, v34
    v_dot2c_f32_bf16 v51, v189, v34
    v_dot2c_f32_bf16 v48, v186, v34
    v_dot2c_f32_bf16 v50, v190, v34
    v_dot2c_f32_bf16 v49, v187, v34
    v_dot2c_f32_bf16 v51, v191, v34
    v_and_b32 v36, 31, v7
    v_lshlrev_b32 v36, 4, v36
    s_lshl_b32 s42, s18, 2
    s_add_u32 s42, s42, 147456
    v_add_u32 v36, s42, v36
    v_add_f32 v48, v48, v49
    v_add_f32 v50, v50, v51
    v_mov_b32 v49, v48
    v_mov_b32 v51, v50
    s_nop 0
    v_permlane32_swap_b32 v48, v49
    v_permlane32_swap_b32 v50, v51
    v_add_f32 v48, v48, v49
    v_add_f32 v50, v50, v51
    ds_write_b32 v36, v48 offset:2560
    ds_write_b32 v36, v50 offset:3072
    s_waitcnt lgkmcnt(0)
Lc77:
    v_add_u32 v35, 114688, v0
    ds_write_b128 v35, v[176:179] offset:0
    ds_write_b128 v35, v[180:183] offset:1024
    ds_write_b128 v35, v[184:187] offset:2048
    ds_write_b128 v35, v[188:191] offset:3072
    s_waitcnt lgkmcnt(0)
    s_barrier
    s_add_u32 m0, s19, 32768
    s_add_u32 s38, s86, 0
    buffer_load_dwordx4 v9, s[28:31], s38 offen lds
    s_add_u32 m0, s19, 33792
    s_add_u32 s38, s86, 64
    buffer_load_dwordx4 v9, s[28:31], s38 offen lds
    s_add_u32 m0, s19, 34816
    s_add_u32 s38, s86, 16448
    buffer_load_dwordx4 v9, s[28:31], s38 offen lds
    s_add_u32 m0, s19, 35840
    s_add_u32 s38, s86, 16384
    buffer_load_dwordx4 v9, s[28:31], s38 offen lds
    s_lshl_b32 s40, s59, 2
    s_add_u32 s40, s40, s18
    s_mul_i32 s40, s40, 12288
    v_lshlrev_b32 v63, 7, v7
    s_mov_b32 exec_lo, 0xffffffff
    s_mov_b32 exec_hi, 0x0
    buffer_load_dword v59, v63, s[8:11], s40 offen
    s_mov_b64 exec, -1
    s_barrier
    s_add_u32 m0, s19, 49152
    s_add_u32 s38, s87, 0
    buffer_load_dwordx4 v9, s[28:31], s38 offen lds
    s_add_u32 m0, s19, 50176
    s_add_u32 s38, s87, 64
    buffer_load_dwordx4 v9, s[28:31], s38 offen lds
    s_add_u32 m0, s19, 51200
    s_add_u32 s38, s87, 16448
    buffer_load_dwordx4 v9, s[28:31], s38 offen lds
    s_add_u32 m0, s19, 52224
    s_add_u32 s38, s87, 16384
    buffer_load_dwordx4 v9, s[28:31], s38 offen lds
    v_add_u32 v35, 131072, v0
    ds_write_b128 v35, v[192:195] offset:0
    ds_write_b128 v35, v[196:199] offset:1024
    ds_write_b128 v35, v[200:203] offset:2048
    ds_write_b128 v35, v[204:207] offset:3072
    v_add_u32 v35, 98304, v0
    ds_write_b128 v35, v[208:211] offset:0
    ds_write_b128 v35, v[212:215] offset:1024
    ds_write_b128 v35, v[216:219] offset:2048
    ds_write_b128 v35, v[220:223] offset:3072
    s_waitcnt lgkmcnt(0)
    s_barrier
    s_add_u32 m0, s19, 65536
    s_add_u32 s38, s88, 0
    buffer_load_dwordx4 v9, s[28:31], s38 offen lds
    s_add_u32 m0, s19, 66560
    s_add_u32 s38, s88, 64
    buffer_load_dwordx4 v9, s[28:31], s38 offen lds
    s_add_u32 m0, s19, 67584
    s_add_u32 s38, s88, 16448
    buffer_load_dwordx4 v9, s[28:31], s38 offen lds
    s_add_u32 m0, s19, 68608
    s_add_u32 s38, s88, 16384
    buffer_load_dwordx4 v9, s[28:31], s38 offen lds
    s_lshl_b32 s40, s59, 2
    s_add_u32 s40, s40, s18
    s_mul_i32 s40, s40, 12288
    s_add_u32 s40, s40, 4096
    v_lshlrev_b32 v63, 7, v7
    s_mov_b32 exec_lo, 0xffffffff
    s_mov_b32 exec_hi, 0x0
    buffer_load_dword v59, v63, s[8:11], s40 offen
    s_mov_b64 exec, -1
    v_mov_b32 v34, 0x3f803f80
    v_mov_b32 v48, 0
    v_mov_b32 v49, 0
    v_mov_b32 v50, 0
    v_mov_b32 v51, 0
    v_dot2c_f32_bf16 v48, v192, v34
    v_dot2c_f32_bf16 v50, v196, v34
    v_dot2c_f32_bf16 v49, v193, v34
    v_dot2c_f32_bf16 v51, v197, v34
    v_dot2c_f32_bf16 v48, v194, v34
    v_dot2c_f32_bf16 v50, v198, v34
    v_dot2c_f32_bf16 v49, v195, v34
    v_dot2c_f32_bf16 v51, v199, v34
    v_dot2c_f32_bf16 v48, v200, v34
    v_dot2c_f32_bf16 v50, v204, v34
    v_dot2c_f32_bf16 v49, v201, v34
    v_dot2c_f32_bf16 v51, v205, v34
    v_dot2c_f32_bf16 v48, v202, v34
    v_dot2c_f32_bf16 v50, v206, v34
    v_dot2c_f32_bf16 v49, v203, v34
    v_dot2c_f32_bf16 v51, v207, v34
    v_dot2c_f32_bf16 v48, v208, v34
    v_dot2c_f32_bf16 v50, v212, v34
    v_dot2c_f32_bf16 v49, v209, v34
    v_dot2c_f32_bf16 v51, v213, v34
    v_dot2c_f32_bf16 v48, v210, v34
    v_dot2c_f32_bf16 v50, v214, v34
    v_dot2c_f32_bf16 v49, v211, v34
    v_dot2c_f32_bf16 v51, v215, v34
    v_dot2c_f32_bf16 v48, v216, v34
    v_dot2c_f32_bf16 v50, v220, v34
    v_dot2c_f32_bf16 v49, v217, v34
    v_dot2c_f32_bf16 v51, v221, v34
    v_dot2c_f32_bf16 v48, v218, v34
    v_dot2c_f32_bf16 v50, v222, v34
    v_dot2c_f32_bf16 v49, v219, v34
    v_dot2c_f32_bf16 v51, v223, v34
Lc78:
    v_add_u32 v35, 114688, v0
    ds_write_b128 v35, v[224:227] offset:0
    ds_write_b128 v35, v[228:231] offset:1024
    ds_write_b128 v35, v[232:235] offset:2048
    ds_write_b128 v35, v[236:239] offset:3072
    s_waitcnt lgkmcnt(0)
    s_barrier
    s_add_u32 m0, s19, 81920
    s_add_u32 s38, s89, 0
    buffer_load_dwordx4 v9, s[28:31], s38 offen lds
    s_add_u32 m0, s19, 82944
    s_add_u32 s38, s89, 64
    buffer_load_dwordx4 v9, s[28:31], s38 offen lds
    s_add_u32 m0, s19, 83968
    s_add_u32 s38, s89, 16448
    buffer_load_dwordx4 v9, s[28:31], s38 offen lds
    s_add_u32 m0, s19, 84992
    s_add_u32 s38, s89, 16384
    buffer_load_dwordx4 v9, s[28:31], s38 offen lds
    v_mov_b32 v34, 0x3f803f80
    v_dot2c_f32_bf16 v48, v224, v34
    v_dot2c_f32_bf16 v50, v228, v34
    v_dot2c_f32_bf16 v49, v225, v34
    v_dot2c_f32_bf16 v51, v229, v34
    v_dot2c_f32_bf16 v48, v226, v34
    v_dot2c_f32_bf16 v50, v230, v34
    v_dot2c_f32_bf16 v49, v227, v34
    v_dot2c_f32_bf16 v51, v231, v34
    v_dot2c_f32_bf16 v48, v232, v34
    v_dot2c_f32_bf16 v50, v236, v34
    v_dot2c_f32_bf16 v49, v233, v34
    v_dot2c_f32_bf16 v51, v237, v34
    v_dot2c_f32_bf16 v48, v234, v34
    v_dot2c_f32_bf16 v50, v238, v34
    v_dot2c_f32_bf16 v49, v235, v34
    v_dot2c_f32_bf16 v51, v239, v34
    v_dot2c_f32_bf16 v48, v240, v34
    v_dot2c_f32_bf16 v50, v244, v34
    v_dot2c_f32_bf16 v49, v241, v34
    v_dot2c_f32_bf16 v51, v245, v34
    v_dot2c_f32_bf16 v48, v242, v34
    v_dot2c_f32_bf16 v50, v246, v34
    v_dot2c_f32_bf16 v49, v243, v34
    v_dot2c_f32_bf16 v51, v247, v34
    v_dot2c_f32_bf16 v48, v248, v34
    v_dot2c_f32_bf16 v50, v252, v34
    v_dot2c_f32_bf16 v49, v249, v34
    v_dot2c_f32_bf16 v51, v253, v34
    v_dot2c_f32_bf16 v48, v250, v34
    v_dot2c_f32_bf16 v50, v254, v34
    v_dot2c_f32_bf16 v49, v251, v34
    v_dot2c_f32_bf16 v51, v255, v34
    v_and_b32 v36, 31, v7
    v_lshlrev_b32 v36, 4, v36
    s_lshl_b32 s42, s18, 2
    s_add_u32 s42, s42, 147456
    v_add_u32 v36, s42, v36
    v_add_f32 v48, v48, v49
    v_add_f32 v50, v50, v51
    v_mov_b32 v49, v48
    v_mov_b32 v51, v50
    s_nop 0
    v_permlane32_swap_b32 v48, v49
    v_permlane32_swap_b32 v50, v51
    v_add_f32 v48, v48, v49
    v_add_f32 v50, v50, v51
    ds_write_b32 v36, v48 offset:3584
    ds_write_b32 v36, v50 offset:4096
    s_waitcnt lgkmcnt(0)
Lc79:
    v_add_u32 v35, 131072, v0
    ds_write_b128 v35, v[240:243] offset:0
    ds_write_b128 v35, v[244:247] offset:1024
    ds_write_b128 v35, v[248:251] offset:2048
    ds_write_b128 v35, v[252:255] offset:3072
    s_waitcnt lgkmcnt(0)
    s_barrier
    s_add_u32 m0, s19, 98304
    s_add_u32 s38, s90, 0
    buffer_load_dwordx4 v9, s[28:31], s38 offen lds
    s_add_u32 m0, s19, 99328
    s_add_u32 s38, s90, 64
    buffer_load_dwordx4 v9, s[28:31], s38 offen lds
    s_add_u32 m0, s19, 100352
    s_add_u32 s38, s90, 16448
    buffer_load_dwordx4 v9, s[28:31], s38 offen lds
    s_add_u32 m0, s19, 101376
    s_add_u32 s38, s90, 16384
    buffer_load_dwordx4 v9, s[28:31], s38 offen lds
    s_lshl_b32 s40, s59, 2
    s_add_u32 s40, s40, s18
    s_mul_i32 s40, s40, 12288
    s_add_u32 s40, s40, 8192
    v_lshlrev_b32 v63, 7, v7
    s_mov_b32 exec_lo, 0xffffffff
    s_mov_b32 exec_hi, 0x0
    buffer_load_dword v59, v63, s[8:11], s40 offen
    s_mov_b64 exec, -1
    s_barrier
    s_add_u32 m0, s19, 114688
    s_add_u32 s38, s91, 0
    buffer_load_dwordx4 v9, s[28:31], s38 offen lds
    s_add_u32 m0, s19, 115712
    s_add_u32 s38, s91, 64
    buffer_load_dwordx4 v9, s[28:31], s38 offen lds
    s_add_u32 m0, s19, 116736
    s_add_u32 s38, s91, 16448
    buffer_load_dwordx4 v9, s[28:31], s38 offen lds
    s_add_u32 m0, s19, 117760
    s_add_u32 s38, s91, 16384
    buffer_load_dwordx4 v9, s[28:31], s38 offen lds
    s_waitcnt vmcnt(28)
    s_waitcnt vmcnt(24)
    s_barrier
    s_add_u32 m0, s19, 131072
    s_add_u32 s38, s92, 0
    buffer_load_dwordx4 v9, s[28:31], s38 offen lds
    s_add_u32 m0, s19, 132096
    s_add_u32 s38, s92, 64
    buffer_load_dwordx4 v9, s[28:31], s38 offen lds
    s_add_u32 m0, s19, 133120
    s_add_u32 s38, s92, 16448
    buffer_load_dwordx4 v9, s[28:31], s38 offen lds
    s_add_u32 m0, s19, 134144
    s_add_u32 s38, s92, 16384
    buffer_load_dwordx4 v9, s[28:31], s38 offen lds
    s_waitcnt vmcnt(24)
    s_barrier
    s_add_u32 m0, s19, 0
    s_add_u32 s38, s93, 0
    buffer_load_dwordx4 v9, s[28:31], s38 offen lds
    s_add_u32 m0, s19, 1024
    s_add_u32 s38, s93, 64
    buffer_load_dwordx4 v9, s[28:31], s38 offen lds
    s_add_u32 m0, s19, 2048
    s_add_u32 s38, s93, 16448
    buffer_load_dwordx4 v9, s[28:31], s38 offen lds
    s_add_u32 m0, s19, 3072
    s_add_u32 s38, s93, 16384
    buffer_load_dwordx4 v9, s[28:31], s38 offen lds
    s_waitcnt vmcnt(24)
    s_barrier
    s_add_u32 m0, s19, 16384
    s_add_u32 s38, s94, 0
    buffer_load_dwordx4 v9, s[28:31], s38 offen lds
    s_add_u32 m0, s19, 17408
    s_add_u32 s38, s94, 64
    buffer_load_dwordx4 v9, s[28:31], s38 offen lds
    s_add_u32 m0, s19, 18432
    s_add_u32 s38, s94, 16448
    buffer_load_dwordx4 v9, s[28:31], s38 offen lds
    s_add_u32 m0, s19, 19456
    s_add_u32 s38, s94, 16384
    buffer_load_dwordx4 v9, s[28:31], s38 offen lds
    s_waitcnt vmcnt(24)
    s_barrier
    s_waitcnt vmcnt(20)
    s_barrier
    s_waitcnt vmcnt(16)
    s_barrier
    s_add_u32 m0, s19, 32768
    s_add_u32 s38, s32, 1024
    buffer_load_dwordx4 v8, s[8:11], s38 offen lds
    s_add_u32 m0, s19, 33792
    s_add_u32 s38, s32, 2048
    buffer_load_dwordx4 v8, s[8:11], s38 offen lds
    s_add_u32 m0, s19, 34816
    s_add_u32 s38, s32, 50176
    buffer_load_dwordx4 v8, s[8:11], s38 offen lds
    s_add_u32 m0, s19, 35840
    s_add_u32 s38, s32, 51200
    buffer_load_dwordx4 v8, s[8:11], s38 offen lds
    s_waitcnt vmcnt(16)
    s_barrier
    s_add_u32 m0, s19, 49152
    s_add_u32 s38, s32, 394240
    buffer_load_dwordx4 v8, s[8:11], s38 offen lds
    s_add_u32 m0, s19, 50176
    s_add_u32 s38, s32, 395264
    buffer_load_dwordx4 v8, s[8:11], s38 offen lds
    s_add_u32 m0, s19, 51200
    s_add_u32 s38, s32, 443392
    buffer_load_dwordx4 v8, s[8:11], s38 offen lds
    s_add_u32 m0, s19, 52224
    s_add_u32 s38, s32, 444416
    buffer_load_dwordx4 v8, s[8:11], s38 offen lds
    s_waitcnt vmcnt(16)
    s_barrier
    s_add_u32 m0, s19, 65536
    s_add_u32 s38, s32, 787456
    buffer_load_dwordx4 v8, s[8:11], s38 offen lds
    s_add_u32 m0, s19, 66560
    s_add_u32 s38, s32, 788480
    buffer_load_dwordx4 v8, s[8:11], s38 offen lds
    s_add_u32 m0, s19, 67584
    s_add_u32 s38, s32, 836608
    buffer_load_dwordx4 v8, s[8:11], s38 offen lds
    s_add_u32 m0, s19, 68608
    s_add_u32 s38, s32, 837632
    buffer_load_dwordx4 v8, s[8:11], s38 offen lds
    s_waitcnt vmcnt(16)
    s_barrier
    s_add_u32 m0, s19, 81920
    s_add_u32 s38, s32, 1180672
    buffer_load_dwordx4 v8, s[8:11], s38 offen lds
    s_add_u32 m0, s19, 82944
    s_add_u32 s38, s32, 1181696
    buffer_load_dwordx4 v8, s[8:11], s38 offen lds
    s_add_u32 m0, s19, 83968
    s_add_u32 s38, s32, 1229824
    buffer_load_dwordx4 v8, s[8:11], s38 offen lds
    s_add_u32 m0, s19, 84992
    s_add_u32 s38, s32, 1230848
    buffer_load_dwordx4 v8, s[8:11], s38 offen lds
    s_waitcnt vmcnt(16)
    s_barrier
    s_add_u32 m0, s19, 98304
    s_add_u32 s38, s33, 0
    buffer_load_dwordx4 v8, s[8:11], s38 offen lds
    s_add_u32 m0, s19, 99328
    s_add_u32 s38, s33, 49152
    buffer_load_dwordx4 v8, s[8:11], s38 offen lds
    s_add_u32 m0, s19, 100352
    s_add_u32 s38, s33, 98304
    buffer_load_dwordx4 v8, s[8:11], s38 offen lds
    s_add_u32 m0, s19, 101376
    s_add_u32 s38, s33, 147456
    buffer_load_dwordx4 v8, s[8:11], s38 offen lds
    s_barrier
    s_add_u32 m0, s19, 114688
    s_add_u32 s38, s33, 786432
    buffer_load_dwordx4 v8, s[8:11], s38 offen lds
    s_add_u32 m0, s19, 115712
    s_add_u32 s38, s33, 835584
    buffer_load_dwordx4 v8, s[8:11], s38 offen lds
    s_add_u32 m0, s19, 116736
    s_add_u32 s38, s33, 884736
    buffer_load_dwordx4 v8, s[8:11], s38 offen lds
    s_add_u32 m0, s19, 117760
    s_add_u32 s38, s33, 933888
    buffer_load_dwordx4 v8, s[8:11], s38 offen lds
    s_barrier
    s_waitcnt vmcnt(20)
    s_waitcnt vmcnt(16)
    s_barrier
    s_waitcnt vmcnt(12)
    s_barrier
    s_waitcnt vmcnt(8)
    s_barrier
    s_barrier
    s_add_u32 m0, s19, 0
    s_add_u32 s38, s34, 0
    buffer_load_dwordx4 v9, s[12:15], s38 offen lds
    s_add_u32 m0, s19, 1024
    s_add_u32 s38, s34, 64
    buffer_load_dwordx4 v9, s[12:15], s38 offen lds
    s_add_u32 m0, s19, 2048
    s_add_u32 s38, s34, 262208
    buffer_load_dwordx4 v9, s[12:15], s38 offen lds
    s_add_u32 m0, s19, 3072
    s_add_u32 s38, s34, 262144
    buffer_load_dwordx4 v9, s[12:15], s38 offen lds
    s_add_u32 m0, s19, 16384
    s_add_u32 s38, s34, 65536
    buffer_load_dwordx4 v9, s[12:15], s38 offen lds
    s_add_u32 m0, s19, 17408
    s_add_u32 s38, s34, 65600
    buffer_load_dwordx4 v9, s[12:15], s38 offen lds
    s_add_u32 m0, s19, 18432
    s_add_u32 s38, s34, 327744
    buffer_load_dwordx4 v9, s[12:15], s38 offen lds
    s_add_u32 m0, s19, 19456
    s_add_u32 s38, s34, 327680
    buffer_load_dwordx4 v9, s[12:15], s38 offen lds
    s_add_u32 m0, s19, 32768
    s_add_u32 s38, s34, 131072
    buffer_load_dwordx4 v9, s[12:15], s38 offen lds
    s_add_u32 m0, s19, 33792
    s_add_u32 s38, s34, 131136
    buffer_load_dwordx4 v9, s[12:15], s38 offen lds
    s_add_u32 m0, s19, 34816
    s_add_u32 s38, s34, 393280
    buffer_load_dwordx4 v9, s[12:15], s38 offen lds
    s_add_u32 m0, s19, 35840
    s_add_u32 s38, s34, 393216
    buffer_load_dwordx4 v9, s[12:15], s38 offen lds
    s_add_u32 m0, s19, 49152
    s_add_u32 s38, s34, 196608
    buffer_load_dwordx4 v9, s[12:15], s38 offen lds
    s_add_u32 m0, s19, 50176
    s_add_u32 s38, s34, 196672
    buffer_load_dwordx4 v9, s[12:15], s38 offen lds
    s_add_u32 m0, s19, 51200
    s_add_u32 s38, s34, 458816
    buffer_load_dwordx4 v9, s[12:15], s38 offen lds
    s_add_u32 m0, s19, 52224
    s_add_u32 s38, s34, 458752
    buffer_load_dwordx4 v9, s[12:15], s38 offen lds
    s_waitcnt vmcnt(20)
    s_waitcnt vmcnt(16)
    s_barrier
    s_lshl_b32 s39, s17, 12
    s_add_u32 s39, s39, 67174400
    v_lshrrev_b32 v56, 4, v7
    v_sub_u32 v56, v7, v56
    v_lshlrev_b32 v56, 2, v56
    s_mul_i32 s40, s18, 240
    s_add_u32 s40, s40, 131072
    v_add_u32 v56, s40, v56
    s_mov_b32 s50, 0x80008000
    s_mov_b32 s51, 0x80008000
    ds_read_b32 v16, v56 offset:0
    ds_read_b32 v17, v56 offset:2304
    ds_read_b32 v18, v56 offset:4608
    ds_read_b32 v19, v56 offset:6912
    ds_read_b32 v20, v56 offset:960
    ds_read_b32 v21, v56 offset:3264
    ds_read_b32 v22, v56 offset:5568
    ds_read_b32 v23, v56 offset:7872
    ds_read_b32 v24, v56 offset:1920
    ds_read_b32 v25, v56 offset:4224
    ds_read_b32 v26, v56 offset:6528
    ds_read_b32 v27, v56 offset:8832
    s_lshl_b32 s40, s18, 8
    s_add_u32 s40, s40, s39
    s_waitcnt lgkmcnt(8)
    v_add_f32 v16, v16, v17
    v_add_f32 v18, v18, v19
    v_add_f32 v16, v16, v18
    v_cndmask_b32 v16, v16, 1.0, s[50:51]
    buffer_atomic_add_f32 v16, v6, s[4:7], s40 offen offset:0 sc1
    s_waitcnt lgkmcnt(4)
    v_add_f32 v20, v20, v21
    v_add_f32 v22, v22, v23
    v_add_f32 v20, v20, v22
    v_cndmask_b32 v20, v20, 1.0, s[50:51]
    buffer_atomic_add_f32 v20, v6, s[4:7], s40 offen offset:1024 sc1
    s_waitcnt lgkmcnt(0)
    v_add_f32 v24, v24, v25
    v_add_f32 v26, v26, v27
    v_add_f32 v24, v24, v26
    v_cndmask_b32 v24, v24, 1.0, s[50:51]
    s_cmp_eq_u32 s18, 0
    s_cselect_b32 s41, -1, 0
    s_cselect_b32 s42, -1, 0
    s_cmp_eq_u32 s18, 1
    s_cselect_b32 s41, 0x800f, s41
    s_cmp_ge_u32 s18, 2
    s_cbranch_scc1 Lq80
    s_mov_b32 exec_lo, s41
    s_mov_b32 exec_hi, s42
    buffer_atomic_add_f32 v24, v6, s[4:7], s40 offen offset:2048 sc1
    s_mov_b64 exec, -1
Lq80:
    s_cmp_lg_u32 s18, 0
    s_cbranch_scc1 Lh81
    v_bfe_u32 v57, v7, 4, 1
    v_lshlrev_b32 v57, 1, v57
    v_lshrrev_b32 v56, 5, v7
    v_add_u32 v57, v57, v56
    s_movk_i32 s40, 4370
    v_add_u32 v28, 0, v7
    v_add_u32 v36, 512, v57
    v_add_u32 v29, 64, v7
    v_add_u32 v37, 516, v57
    v_add_u32 v30, 128, v7
    v_add_u32 v38, 520, v57
    v_add_u32 v31, 192, v7
    v_add_u32 v39, 524, v57
    v_add_u32 v32, 256, v7
    v_add_u32 v40, 528, v57
    v_add_u32 v33, 320, v7
    v_add_u32 v41, 532, v57
    v_add_u32 v34, 384, v7
    v_add_u32 v42, 536, v57
    v_add_u32 v35, 448, v7
    v_add_u32 v43, 540, v57
    v_mul_u32_u24 v56, s40, v28
    v_lshrrev_b32 v56, 16, v56
    v_add_u32 v28, v28, v56
    v_lshlrev_b32 v28, 2, v28
    v_add_u32 v28, 140288, v28
    v_mul_u32_u24 v56, s40, v29
    v_lshrrev_b32 v56, 16, v56
    v_add_u32 v29, v29, v56
    v_lshlrev_b32 v29, 2, v29
    v_add_u32 v29, 140288, v29
    v_mul_u32_u24 v56, s40, v30
    v_lshrrev_b32 v56, 16, v56
    v_add_u32 v30, v30, v56
    v_lshlrev_b32 v30, 2, v30
    v_add_u32 v30, 140288, v30
    v_mul_u32_u24 v56, s40, v31
    v_lshrrev_b32 v56, 16, v56
    v_add_u32 v31, v31, v56
    v_lshlrev_b32 v31, 2, v31
    v_add_u32 v31, 140288, v31
    v_mul_u32_u24 v56, s40, v32
    v_lshrrev_b32 v56, 16, v56
    v_add_u32 v32, v32, v56
    v_lshlrev_b32 v32, 2, v32
    v_add_u32 v32, 140288, v32
    v_mul_u32_u24 v56, s40, v33
    v_lshrrev_b32 v56, 16, v56
    v_add_u32 v33, v33, v56
    v_lshlrev_b32 v33, 2, v33
    v_add_u32 v33, 140288, v33
    v_mul_u32_u24 v56, s40, v34
    v_lshrrev_b32 v56, 16, v56
    v_add_u32 v34, v34, v56
    v_lshlrev_b32 v34, 2, v34
    v_add_u32 v34, 140288, v34
    v_mul_u32_u24 v56, s40, v35
    v_lshrrev_b32 v56, 16, v56
    v_add_u32 v35, v35, v56
    v_lshlrev_b32 v35, 2, v35
    v_add_u32 v35, 140288, v35
    v_mul_u32_u24 v56, s40, v36
    v_lshrrev_b32 v56, 16, v56
    v_add_u32 v36, v36, v56
    v_lshlrev_b32 v36, 2, v36
    v_add_u32 v36, 140288, v36
    v_mul_u32_u24 v56, s40, v37
    v_lshrrev_b32 v56, 16, v56
    v_add_u32 v37, v37, v56
    v_lshlrev_b32 v37, 2, v37
    v_add_u32 v37, 140288, v37
    v_mul_u32_u24 v56, s40, v38
    v_lshrrev_b32 v56, 16, v56
    v_add_u32 v38, v38, v56
    v_lshlrev_b32 v38, 2, v38
    v_add_u32 v38, 140288, v38
    v_mul_u32_u24 v56, s40, v39
    v_lshrrev_b32 v56, 16, v56
    v_add_u32 v39, v39, v56
    v_lshlrev_b32 v39, 2, v39
    v_add_u32 v39, 140288, v39
    v_mul_u32_u24 v56, s40, v40
    v_lshrrev_b32 v56, 16, v56
    v_add_u32 v40, v40, v56
    v_lshlrev_b32 v40, 2, v40
    v_add_u32 v40, 140288, v40
    v_mul_u32_u24 v56, s40, v41
    v_lshrrev_b32 v56, 16, v56
    v_add_u32 v41, v41, v56
    v_lshlrev_b32 v41, 2, v41
    v_add_u32 v41, 140288, v41
    v_mul_u32_u24 v56, s40, v42
    v_lshrrev_b32 v56, 16, v56
    v_add_u32 v42, v42, v56
    v_lshlrev_b32 v42, 2, v42
    v_add_u32 v42, 140288, v42
    v_mul_u32_u24 v56, s40, v43
    v_lshrrev_b32 v56, 16, v56
    v_add_u32 v43, v43, v56
    v_lshlrev_b32 v43, 2, v43
    v_add_u32 v43, 140288, v43
    s_mov_b32 s52, 0x88888888
    s_mov_b32 s53, 0x88888888
    s_mov_b32 s54, 0x00088888
    s_mov_b32 s55, 0
    s_mov_b32 s41, 0x41800000
    s_mov_b32 s48, 0
Lk82:
    buffer_load_dwordx4 v[16:19], v1, s[4:7], s39 offen offset:0 sc1
    buffer_load_dwordx4 v[20:23], v1, s[4:7], s39 offen offset:1024 sc1
    buffer_load_dwordx4 v[24:27], v1, s[4:7], s39 offen offset:2048 sc1
    s_waitcnt vmcnt(0)
    v_cmp_eq_u32 vcc, s41, v19
    s_nop 1
    s_and_b64 s[60:61], vcc, s[52:53]
    s_cmp_eq_u64 s[60:61], s[52:53]
    s_cbranch_scc0 Lk84
    v_cmp_eq_u32 vcc, s41, v23
    s_nop 1
    s_and_b64 s[60:61], vcc, s[52:53]
    s_cmp_eq_u64 s[60:61], s[52:53]
    s_cbranch_scc0 Lk84
    v_cmp_eq_u32 vcc, s41, v27
    s_nop 1
    s_and_b64 s[60:61], vcc, s[54:55]
    s_cmp_eq_u64 s[60:61], s[54:55]
    s_cbranch_scc0 Lk84
    s_branch Lk83
Lk84:
    s_add_u32 s48, s48, 1
    s_cmp_lt_u32 s48, 400000
    s_cbranch_scc1 Lk82
    s_mov_b32 s49, 1
Lk83:
    v_add_u32 v56, 140288, v1
    ds_write_b128 v56, v[16:19] offset:0
    ds_write_b128 v56, v[20:23] offset:1024
    ds_write_b128 v56, v[24:27] offset:2048
    v_and_b32 v57, 16, v7
    v_cmp_eq_u32 vcc, 0, v57
    s_waitcnt lgkmcnt(0)
    ds_read_b32 v28, v28
    ds_read_b32 v29, v29
    ds_read_b32 v30, v30
    ds_read_b32 v31, v31
    ds_read_b32 v32, v32
    ds_read_b32 v33, v33
    ds_read_b32 v34, v34
    ds_read_b32 v35, v35
    ds_read_b32 v36, v36
    ds_read_b32 v37, v37
    ds_read_b32 v38, v38
    ds_read_b32 v39, v39
    ds_read_b32 v40, v40
    ds_read_b32 v41, v41
    ds_read_b32 v42, v42
    ds_read_b32 v43, v43
    v_add_u32 v56, 153088, v1
    s_waitcnt lgkmcnt(8)
    v_cvt_pk_bf16_f32 v16, v28, v29
    v_cvt_pk_bf16_f32 v17, v30, v31
    v_cvt_pk_bf16_f32 v18, v32, v33
    v_cvt_pk_bf16_f32 v19, v34, v35
    v_cndmask_b32 v20, 0, v16, vcc
    v_cndmask_b32 v21, 0, v17, vcc
    v_cndmask_b32 v22, 0, v18, vcc
    v_cndmask_b32 v23, 0, v19, vcc
    v_xor_b32 v16, v16, v20
    v_xor_b32 v17, v17, v21
    v_xor_b32 v18, v18, v22
    v_xor_b32 v19, v19, v23
    ds_write_b128 v56, v[20:23]
    ds_write_b128 v56, v[16:19] offset:1024
    s_waitcnt lgkmcnt(2)
    v_cvt_pk_bf16_f32 v24, v36, v37
    v_cvt_pk_bf16_f32 v25, v38, v39
    v_cvt_pk_bf16_f32 v26, v40, v41
    v_cvt_pk_bf16_f32 v27, v42, v43
    v_cndmask_b32 v44, 0, v24, vcc
    v_cndmask_b32 v45, 0, v25, vcc
    v_cndmask_b32 v46, 0, v26, vcc
    v_cndmask_b32 v47, 0, v27, vcc
    v_xor_b32 v24, v24, v44
    v_xor_b32 v25, v25, v45
    v_xor_b32 v26, v26, v46
    v_xor_b32 v27, v27, v47
    ds_write_b128 v56, v[44:47] offset:2048
    ds_write_b128 v56, v[24:27] offset:3072
    s_waitcnt lgkmcnt(0)
Lh81:
    s_waitcnt vmcnt(14)
    s_waitcnt vmcnt(10)
    s_waitcnt vmcnt(6)
    s_waitcnt vmcnt(2)
    s_barrier
    s_barrier
    v_add_u32 v35, 98304, v0
    ds_write_b128 v35, v[64:67] offset:0
    ds_write_b128 v35, v[68:71] offset:1024
    ds_write_b128 v35, v[72:75] offset:2048
    ds_write_b128 v35, v[76:79] offset:3072
    v_add_u32 v35, 114688, v0
    ds_write_b128 v35, v[80:83] offset:0
    ds_write_b128 v35, v[84:87] offset:1024
    ds_write_b128 v35, v[88:91] offset:2048
    ds_write_b128 v35, v[92:95] offset:3072
    s_waitcnt lgkmcnt(0)
    s_barrier
    v_add_u32 v35, 131072, v0
    ds_write_b128 v35, v[96:99] offset:0
    ds_write_b128 v35, v[100:103] offset:1024
    ds_write_b128 v35, v[104:107] offset:2048
    ds_write_b128 v35, v[108:111] offset:3072
    s_waitcnt lgkmcnt(0)
    s_barrier
    v_add_u32 v35, 98304, v0
    ds_write_b128 v35, v[112:115] offset:0
    ds_write_b128 v35, v[116:119] offset:1024
    ds_write_b128 v35, v[120:123] offset:2048
    ds_write_b128 v35, v[124:127] offset:3072
    s_waitcnt lgkmcnt(0)
    s_barrier
    s_barrier
    v_add_u32 v35, 114688, v0
    ds_write_b128 v35, v[128:131] offset:0
    ds_write_b128 v35, v[132:135] offset:1024
    ds_write_b128 v35, v[136:139] offset:2048
    ds_write_b128 v35, v[140:143] offset:3072
    v_add_u32 v35, 131072, v0
    ds_write_b128 v35, v[144:147] offset:0
    ds_write_b128 v35, v[148:151] offset:1024
    ds_write_b128 v35, v[152:155] offset:2048
    ds_write_b128 v35, v[156:159] offset:3072
    s_waitcnt lgkmcnt(0)
    s_barrier
    s_add_u32 m0, s19, 0
    s_add_u32 s38, s84, 0
    buffer_load_dwordx4 v9, s[28:31], s38 offen lds
    s_add_u32 m0, s19, 1024
    s_add_u32 s38, s84, 64
    buffer_load_dwordx4 v9, s[28:31], s38 offen lds
    s_add_u32 m0, s19, 2048
    s_add_u32 s38, s84, 16448
    buffer_load_dwordx4 v9, s[28:31], s38 offen lds
    s_add_u32 m0, s19, 3072
    s_add_u32 s38, s84, 16384
    buffer_load_dwordx4 v9, s[28:31], s38 offen lds
    v_add_u32 v35, 98304, v0
    ds_write_b128 v35, v[160:163] offset:0
    ds_write_b128 v35, v[164:167] offset:1024
    ds_write_b128 v35, v[168:171] offset:2048
    ds_write_b128 v35, v[172:175] offset:3072
    s_waitcnt lgkmcnt(0)
    s_barrier
    s_add_u32 m0, s19, 16384
    s_add_u32 s38, s85, 0
    buffer_load_dwordx4 v9, s[28:31], s38 offen lds
    s_add_u32 m0, s19, 17408
    s_add_u32 s38, s85, 64
    buffer_load_dwordx4 v9, s[28:31], s38 offen lds
    s_add_u32 m0, s19, 18432
    s_add_u32 s38, s85, 16448
    buffer_load_dwordx4 v9, s[28:31], s38 offen lds
    s_add_u32 m0, s19, 19456
    s_add_u32 s38, s85, 16384
    buffer_load_dwordx4 v9, s[28:31], s38 offen lds
    v_add_u32 v35, 114688, v0
    ds_write_b128 v35, v[176:179] offset:0
    ds_write_b128 v35, v[180:183] offset:1024
    ds_write_b128 v35, v[184:187] offset:2048
    ds_write_b128 v35, v[188:191] offset:3072
    s_waitcnt lgkmcnt(0)
    s_barrier
    s_add_u32 m0, s19, 32768
    s_add_u32 s38, s86, 0
    buffer_load_dwordx4 v9, s[28:31], s38 offen lds
    s_add_u32 m0, s19, 33792
    s_add_u32 s38, s86, 64
    buffer_load_dwordx4 v9, s[28:31], s38 offen lds
    s_add_u32 m0, s19, 34816
    s_add_u32 s38, s86, 16448
    buffer_load_dwordx4 v9, s[28:31], s38 offen lds
    s_add_u32 m0, s19, 35840
    s_add_u32 s38, s86, 16384
    buffer_load_dwordx4 v9, s[28:31], s38 offen lds
    s_cmp_ge_u32 s18, 2
    s_cbranch_scc1 Lo85
    s_lshl_b32 s40, s16, 17
    s_lshr_b32 s41, s17, 3
    s_lshl_b32 s41, s41, 16
    s_add_u32 s40, s40, s41
    s_lshl_b32 s41, s18, 15
    s_add_u32 s40, s40, s41
    s_and_b32 s41, s17, 7
    s_lshl_b32 s41, s41, 7
    s_add_u32 s40, s40, s41
    v_lshlrev_b32 v63, 10, v7
    v_add_u32 v63, s40, v63
    s_mov_b32 exec_hi, 0
    global_load_dword v59, v63, s[78:79]
    s_mov_b64 exec, -1
Lo85:
    s_barrier
    s_add_u32 m0, s19, 49152
    s_add_u32 s38, s87, 0
    buffer_load_dwordx4 v9, s[28:31], s38 offen lds
    s_add_u32 m0, s19, 50176
    s_add_u32 s38, s87, 64
    buffer_load_dwordx4 v9, s[28:31], s38 offen lds
    s_add_u32 m0, s19, 51200
    s_add_u32 s38, s87, 16448
    buffer_load_dwordx4 v9, s[28:31], s38 offen lds
    s_add_u32 m0, s19, 52224
    s_add_u32 s38, s87, 16384
    buffer_load_dwordx4 v9, s[28:31], s38 offen lds
    v_add_u32 v35, 131072, v0
    ds_write_b128 v35, v[192:195] offset:0
    ds_write_b128 v35, v[196:199] offset:1024
    ds_write_b128 v35, v[200:203] offset:2048
    ds_write_b128 v35, v[204:207] offset:3072
    v_add_u32 v35, 98304, v0
    ds_write_b128 v35, v[208:211] offset:0
    ds_write_b128 v35, v[212:215] offset:1024
    ds_write_b128 v35, v[216:219] offset:2048
    ds_write_b128 v35, v[220:223] offset:3072
    s_waitcnt lgkmcnt(0)
    s_barrier
    s_add_u32 m0, s19, 65536
    s_add_u32 s38, s88, 0
    buffer_load_dwordx4 v9, s[28:31], s38 offen lds
    s_add_u32 m0, s19, 66560
    s_add_u32 s38, s88, 64
    buffer_load_dwordx4 v9, s[28:31], s38 offen lds
    s_add_u32 m0, s19, 67584
    s_add_u32 s38, s88, 16448
    buffer_load_dwordx4 v9, s[28:31], s38 offen lds
    s_add_u32 m0, s19, 68608
    s_add_u32 s38, s88, 16384
    buffer_load_dwordx4 v9, s[28:31], s38 offen lds
    v_add_u32 v35, 114688, v0
    ds_write_b128 v35, v[224:227] offset:0
    ds_write_b128 v35, v[228:231] offset:1024
    ds_write_b128 v35, v[232:235] offset:2048
    ds_write_b128 v35, v[236:239] offset:3072
    s_waitcnt lgkmcnt(0)
    s_barrier
    s_add_u32 m0, s19, 81920
    s_add_u32 s38, s89, 0
    buffer_load_dwordx4 v9, s[28:31], s38 offen lds
    s_add_u32 m0, s19, 82944
    s_add_u32 s38, s89, 64
    buffer_load_dwordx4 v9, s[28:31], s38 offen lds
    s_add_u32 m0, s19, 83968
    s_add_u32 s38, s89, 16448
    buffer_load_dwordx4 v9, s[28:31], s38 offen lds
    s_add_u32 m0, s19, 84992
    s_add_u32 s38, s89, 16384
    buffer_load_dwordx4 v9, s[28:31], s38 offen lds
    v_add_u32 v35, 131072, v0
    ds_write_b128 v35, v[240:243] offset:0
    ds_write_b128 v35, v[244:247] offset:1024
    ds_write_b128 v35, v[248:251] offset:2048
    ds_write_b128 v35, v[252:255] offset:3072
    s_waitcnt lgkmcnt(0)
    s_barrier
    s_add_u32 m0, s19, 98304
    s_add_u32 s38, s90, 0
    buffer_load_dwordx4 v9, s[28:31], s38 offen lds
    s_add_u32 m0, s19, 99328
    s_add_u32 s38, s90, 64
    buffer_load_dwordx4 v9, s[28:31], s38 offen lds
    s_add_u32 m0, s19, 100352
    s_add_u32 s38, s90, 16448
    buffer_load_dwordx4 v9, s[28:31], s38 offen lds
    s_add_u32 m0, s19, 101376
    s_add_u32 s38, s90, 16384
    buffer_load_dwordx4 v9, s[28:31], s38 offen lds
    s_barrier
    s_add_u32 m0, s19, 114688
    s_add_u32 s38, s91, 0
    buffer_load_dwordx4 v9, s[28:31], s38 offen lds
    s_add_u32 m0, s19, 115712
    s_add_u32 s38, s91, 64
    buffer_load_dwordx4 v9, s[28:31], s38 offen lds
    s_add_u32 m0, s19, 116736
    s_add_u32 s38, s91, 16448
    buffer_load_dwordx4 v9, s[28:31], s38 offen lds
    s_add_u32 m0, s19, 117760
    s_add_u32 s38, s91, 16384
    buffer_load_dwordx4 v9, s[28:31], s38 offen lds
    s_waitcnt vmcnt(28)
    s_waitcnt vmcnt(24)
    s_barrier
    s_add_u32 m0, s19, 131072
    s_add_u32 s38, s92, 0
    buffer_load_dwordx4 v9, s[28:31], s38 offen lds
    s_add_u32 m0, s19, 132096
    s_add_u32 s38, s92, 64
    buffer_load_dwordx4 v9, s[28:31], s38 offen lds
    s_add_u32 m0, s19, 133120
    s_add_u32 s38, s92, 16448
    buffer_load_dwordx4 v9, s[28:31], s38 offen lds
    s_add_u32 m0, s19, 134144
    s_add_u32 s38, s92, 16384
    buffer_load_dwordx4 v9, s[28:31], s38 offen lds
    s_waitcnt vmcnt(24)
    s_barrier
    s_add_u32 m0, s19, 0
    s_add_u32 s38, s93, 0
    buffer_load_dwordx4 v9, s[28:31], s38 offen lds
    s_add_u32 m0, s19, 1024
    s_add_u32 s38, s93, 64
    buffer_load_dwordx4 v9, s[28:31], s38 offen lds
    s_add_u32 m0, s19, 2048
    s_add_u32 s38, s93, 16448
    buffer_load_dwordx4 v9, s[28:31], s38 offen lds
    s_add_u32 m0, s19, 3072
    s_add_u32 s38, s93, 16384
    buffer_load_dwordx4 v9, s[28:31], s38 offen lds
    s_waitcnt vmcnt(24)
    s_barrier
    s_add_u32 m0, s19, 16384
    s_add_u32 s38, s94, 0
    buffer_load_dwordx4 v9, s[28:31], s38 offen lds
    s_add_u32 m0, s19, 17408
    s_add_u32 s38, s94, 64
    buffer_load_dwordx4 v9, s[28:31], s38 offen lds
    s_add_u32 m0, s19, 18432
    s_add_u32 s38, s94, 16448
    buffer_load_dwordx4 v9, s[28:31], s38 offen lds
    s_add_u32 m0, s19, 19456
    s_add_u32 s38, s94, 16384
    buffer_load_dwordx4 v9, s[28:31], s38 offen lds
    s_waitcnt vmcnt(24)
    s_barrier
    s_waitcnt vmcnt(20)
    s_barrier
    s_waitcnt vmcnt(16)
    s_barrier
    s_waitcnt vmcnt(12)
    s_barrier
    s_waitcnt vmcnt(8)
    s_barrier
    s_waitcnt vmcnt(4)
    s_barrier
    s_waitcnt vmcnt(0)
    s_barrier
    s_barrier
    s_barrier
    s_branch L_end
Lsl7:
    buffer_wbl2 sc1
    s_waitcnt vmcnt(0)
    s_add_u32 s28, s28, 16
    v_mov_b32 v12, s28
    s_mov_b64 exec, 1
    buffer_store_dword v12, v11, s[4:7], s29 offen sc0 sc1
    s_mov_b64 exec, -1
    s_add_u32 s27, s27, 16
    s_mov_b32 s48, 0
Lp9:
    buffer_load_dword v9, v8, s[4:7], s24 offen sc1
    s_waitcnt vmcnt(0)
    v_subrev_u32 v9, s27, v9
    v_cmp_gt_u32 vcc, 16, v9
    s_nop 1
    s_cmp_eq_u64 vcc, -1
    s_cbranch_scc1 Lpd10
    s_add_u32 s48, s48, 1
    s_cmp_lt_u32 s48, 400000
    s_cbranch_scc1 Lp9
    s_mov_b32 s49, 1
Lpd10:
    s_branch Lsb8
Liv11:
    buffer_inv sc1
    s_waitcnt vmcnt(0)
    s_branch Lik12
Lsg13:
    buffer_wbl2 sc1
    s_waitcnt vmcnt(0)
    s_mov_b64 exec, 1
    buffer_store_dword v12, v11, s[4:7], s51 offen sc0 sc1
    s_mov_b64 exec, -1
    s_branch Lsb14
Lwi15:
    buffer_inv sc1
    s_waitcnt vmcnt(0)
    s_branch Lwb16
Lsg21:
    buffer_wbl2 sc1
    s_waitcnt vmcnt(0)
    s_mov_b64 exec, 1
    buffer_store_dword v12, v11, s[4:7], s51 offen sc0 sc1
    s_mov_b64 exec, -1
    s_branch Lsb22
Lwi23:
    buffer_inv sc1
    s_waitcnt vmcnt(0)
    s_branch Lwb24
Lsg27:
    buffer_wbl2 sc1
    s_waitcnt vmcnt(0)
    s_mov_b64 exec, 1
    buffer_store_dword v12, v11, s[4:7], s51 offen sc0 sc1
    s_mov_b64 exec, -1
    s_branch Lsb28
Lac29:
    s_mov_b32 s48, 0
Lap32:
    buffer_load_dword v13, v6, s[4:7], s44 offen sc1
    s_waitcnt vmcnt(0)
    v_subrev_u32 v13, s30, v13
    v_cmp_gt_u32 vcc, 0x400, v13
    s_nop 1
    s_cmp_eq_u64 vcc, -1
    s_cbranch_scc1 Lab30
    s_add_u32 s48, s48, 1
    s_cmp_lt_u32 s48, 400000
    s_cbranch_scc1 Lap32
    s_mov_b32 s49, 1
    s_branch Lab30
Lai31:
    buffer_inv sc1
    s_waitcnt vmcnt(0)
    s_branch Lad33
Lsg34:
    buffer_wbl2 sc1
    s_waitcnt vmcnt(0)
    s_mov_b64 exec, 1
    buffer_store_dword v12, v11, s[4:7], s51 offen sc0 sc1
    s_mov_b64 exec, -1
    s_branch Lsb35
Lac36:
    s_mov_b32 s48, 0
Lap39:
    buffer_load_dword v13, v6, s[4:7], s44 offen sc1
    s_waitcnt vmcnt(0)
    v_subrev_u32 v13, s30, v13
    v_cmp_gt_u32 vcc, 0x400, v13
    s_nop 1
    s_cmp_eq_u64 vcc, -1
    s_cbranch_scc1 Lab37
    s_add_u32 s48, s48, 1
    s_cmp_lt_u32 s48, 400000
    s_cbranch_scc1 Lap39
    s_mov_b32 s49, 1
    s_branch Lab37
Lai38:
    buffer_inv sc1
    s_waitcnt vmcnt(0)
    s_branch Lad40
Lsg41:
    buffer_wbl2 sc1
    s_waitcnt vmcnt(0)
    s_mov_b64 exec, 1
    buffer_store_dword v12, v11, s[4:7], s51 offen sc0 sc1
    s_mov_b64 exec, -1
    s_branch Lsb42
Lac43:
    s_mov_b32 s48, 0
Lap46:
    buffer_load_dword v13, v6, s[4:7], s44 offen sc1
    s_waitcnt vmcnt(0)
    v_subrev_u32 v13, s30, v13
    v_cmp_gt_u32 vcc, 0x400, v13
    s_nop 1
    s_cmp_eq_u64 vcc, -1
    s_cbranch_scc1 Lab44
    s_add_u32 s48, s48, 1
    s_cmp_lt_u32 s48, 400000
    s_cbranch_scc1 Lap46
    s_mov_b32 s49, 1
    s_branch Lab44
Lai45:
    buffer_inv sc1
    s_waitcnt vmcnt(0)
    s_branch Lad47
Lsg50:
    buffer_wbl2 sc1
    s_waitcnt vmcnt(0)
    s_mov_b64 exec, 1
    buffer_store_dword v12, v11, s[4:7], s51 offen sc0 sc1
    s_mov_b64 exec, -1
    s_branch Lsb51
Lwi52:
    buffer_inv sc1
    s_waitcnt vmcnt(0)
    s_branch Lwb53
L_end:
    s_endpgm
.section .rodata,"a"
.p2align 6
.amdhsa_kernel interleave_layers__linear_attn_block__glu_gated_geglu__prompt_kernel
  .amdhsa_next_free_vgpr 256
  .amdhsa_next_free_sgpr 102
  .amdhsa_accum_offset 256
  .amdhsa_group_segment_fixed_size 0
  .amdhsa_kernarg_size 80
  .amdhsa_user_sgpr_count 2
  .amdhsa_user_sgpr_kernarg_segment_ptr 1
  .amdhsa_system_sgpr_workgroup_id_x 1
.end_amdhsa_kernel
```
